```python
import torch

def _softmax(x, axis=-1):
    return torch.softmax(x, dim=axis)
def _gelu(x):
    return torch.nn.functional.gelu(x, approximate="tanh")
def _silu(x):
    return torch.nn.functional.silu(x)
def _sigmoid(x):
    return torch.sigmoid(x)
def _layernorm(x, axis=-1, eps=1e-5):
    m = x.mean(dim=axis, keepdim=True)
    v = x.var(dim=axis, keepdim=True, unbiased=False)
    return (x - m) / torch.sqrt(v + eps)
def _scatter_add(tgt, idx, src, axis=0):
    return tgt.clone().index_add_(axis, idx, src)
def _segment_sum(src, seg, n):
    out = torch.zeros((n,) + src.shape[1:], dtype=src.dtype)
    return out.index_add_(0, seg, src)
def _pad(x, pw):
    flat = tuple(v for pair in reversed(pw) for v in pair)
    return torch.nn.functional.pad(x, flat)

kernel_name = 'standalone__mha_block_cached__sampling'

def setup_inputs():

    _w = (lambda a: (lambda t: t.to(torch.bfloat16) if t.is_floating_point() else t)(torch.as_tensor(a)))
    B, Sq, D = 16, 8, 1024
    H, Sk, Dh = 32, 2048, 128
    return {
        "x": _w((lambda *s: torch.randn(*s, dtype=torch.bfloat16) * 0.8)(B, Sq, D)),
        "k_cache": _w((lambda *s: torch.randn(*s, dtype=torch.bfloat16) * 0.8)(B, H, Sk, Dh)),
        "v_cache": _w((lambda *s: torch.randn(*s, dtype=torch.bfloat16) * 0.05)(B, H, Sk, Dh)),
        "wq": _w((lambda *s: torch.randn(*s, dtype=torch.bfloat16) * 0.8)(D, H * Dh) * (D ** -0.5)),
        "wo": _w((lambda *s: torch.randn(*s, dtype=torch.bfloat16) * 0.05)(H * Dh, D) * ((H * Dh) ** -0.5)),
    }

def reference(x, k_cache, v_cache, wq, wo):
    B, Sq, D = x.shape
    H, Dh = 32, 128
    q = (lambda x, *d: x.permute(*d))((x @ wq).reshape(B, Sq, H, Dh), 0, 2, 1, 3)
    scores = torch.einsum("bhqd,bhkd->bhqk", q, k_cache) * (Dh ** -0.5)
    p = _softmax(scores, axis=-1)
    o = torch.einsum("bhqk,bhkd->bhqd", p, v_cache)
    return (lambda x, *d: x.permute(*d))(o, 0, 2, 1, 3).reshape(B, Sq, H * Dh) @ wo
```

```asm
; @launch grid=(256,1,1) block=(512,1,1) lds=161088
.amdgcn_target "amdgcn-amd-amdhsa--gfx950"
.text
.globl standalone__mha_block_cached__sampling_kernel
.p2align 8
.type standalone__mha_block_cached__sampling_kernel,@function
standalone__mha_block_cached__sampling_kernel:
  s_cmp_ge_u32 s2, 256
  s_cbranch_scc1 L_end
  s_load_dwordx16 s[4:19], s[0:1], 0
  v_lshrrev_b32 v8, 6, v0
  v_and_b32 v11, 63, v0
  v_readfirstlane_b32 s52, v8
  s_and_b32 s61, s2, 7
  s_bfe_u32 s62, s2, 0x20003
  s_lshl_b32 s53, s61, 2
  s_or_b32 s53, s53, s62
  s_lshr_b32 s54, s2, 5
  s_lshr_b32 s55, s53, 2
  s_and_b32 s3, s53, 3
  v_and_b32 v8, 15, v11
  v_lshrrev_b32 v9, 4, v11
  v_bfe_u32 v1, v11, 4, 1
  v_lshlrev_b32 v1, 17, v1
  v_bfe_u32 v2, v11, 2, 1
  v_lshl_add_u32 v1, v2, 9, v1
  v_bfe_u32 v2, v11, 3, 1
  v_lshl_add_u32 v1, v2, 13, v1
  v_lshrrev_b32 v2, 5, v11
  v_lshl_add_u32 v1, v2, 6, v1
  v_and_b32 v2, 3, v11
  v_lshl_add_u32 v1, v2, 4, v1
  v_lshlrev_b32 v3, 4, v11
  s_lshl_b32 s99, s2, 3
  s_or_b32 s99, s99, s52
  s_mov_b32 s96, 0
  s_and_b32 s97, s99, 0xc0
  s_bcnt1_i32_b32 s97, s97
  s_and_b32 s97, s97, 1
  s_lshl_b32 s97, s97, 11
  s_add_u32 s96, s96, s97
  s_bfe_u32 s97, s99, 0x10002
  s_lshl_b32 s97, s97, 16
  s_add_u32 s96, s96, s97
  s_mov_b32 s75, 7
  s_and_b32 s97, s99, 0x140
  s_bcnt1_i32_b32 s97, s97
  s_and_b32 s97, s97, 1
  s_add_u32 s75, s75, s97
  s_and_b32 s97, s99, 0x220
  s_bcnt1_i32_b32 s97, s97
  s_and_b32 s97, s97, 1
  s_lshl1_add_u32 s75, s97, s75
  s_bfe_u32 s97, s99, 0x1000a
  s_lshl2_add_u32 s75, s97, s75
  s_xor_b32 s97, s96, 2048
  s_xor_b32 s98, s96, 65536
  s_xor_b32 s99, s96, 67584
  s_lshl_b32 s63, s54, 6
  s_add_u32 s63, s63, s53
  s_lshl_b32 s74, s63, 19
  s_bfe_u32 s63, s52, 0x10000
  s_lshl_b32 s63, s63, 12
  s_add_u32 s74, s74, s63
  s_bfe_u32 s63, s52, 0x10001
  s_lshl_b32 s63, s63, 15
  s_add_u32 s74, s74, s63
  s_bfe_u32 s63, s52, 0x10002
  s_lshl_b32 s63, s63, 8
  s_add_u32 s74, s74, s63
  s_mov_b32 s56, -1
  s_mov_b32 s22, 0x10000000
  s_mov_b32 s23, 0x00020000
  s_add_u32 s56, s56, 1
  s_and_b32 s57, s56, 8
  s_lshl_b32 s57, s57, 21
  s_add_u32 s57, s57, s74
  s_add_u32 s75, s75, 1
  s_bfe_u32 s64, s75, 0x10000
  s_lshl_b32 s64, s64, 10
  s_add_u32 s57, s57, s64
  s_bfe_u32 s64, s75, 0x10001
  s_lshl_b32 s64, s64, 18
  s_add_u32 s57, s57, s64
  s_bfe_u32 s64, s75, 0x10002
  s_lshl_b32 s64, s64, 14
  s_add_u32 s57, s57, s64
  s_add_u32 s63, s57, s96
  s_waitcnt lgkmcnt(0)
  s_mov_b64 s[20:21], s[6:7]
  buffer_load_dwordx4 v[136:139], v1, s[20:23], s63 offen offset:0 nt
  v_lshlrev_b32 v5, 16, v9
  v_lshl_add_u32 v5, v8, 4, v5
  v_lshlrev_b32 v6, 11, v8
  v_lshl_add_u32 v6, v9, 4, v6
  v_mov_b32 v40, -1
  v_mov_b32 v41, -1
  v_mov_b32 v42, -1
  v_mov_b32 v43, -1
  s_lshl_b32 s65, s54, 15
  s_lshl_b32 s80, s52, 8
  s_add_u32 s65, s65, s80
  s_lshl_b32 s80, s52, 20
  s_lshl_b32 s81, s53, 8
  s_add_u32 s66, s80, s81
  s_lshl_b32 s81, s54, 5
  s_add_u32 s81, s81, s53
  s_mul_i32 s69, s81, 12416
  s_and_b32 s101, s2, 7
  s_bfe_u32 s61, s2, 0x10004
  s_lshl_b32 s61, s61, 3
  s_add_u32 s101, s101, s61
  s_and_b32 s61, s2, 0xe8
  s_cselect_b32 s101, 99, s101
  s_mov_b32 s34, 0x40000
  s_mov_b32 s35, 0x00020000
  s_mov_b32 s30, 0x800000
  s_mov_b32 s31, 0x00020000
  s_mov_b32 s42, 0x310000
  s_mov_b32 s43, 0x00020000
  s_mov_b64 s[32:33], s[4:5]
  s_mov_b64 s[28:29], s[10:11]
  s_mov_b64 s[40:41], s[18:19]
  buffer_load_dwordx4 v[32:35], v6, s[32:35], s65 offen offset:0
  buffer_load_dwordx4 v[36:39], v6, s[32:35], s65 offen offset:64
  s_add_u32 s64, s66, 0x0
  buffer_load_dwordx4 v[72:75], v5, s[28:31], s64 offen nt
  s_lshl_b32 s62, s52, 10
  s_add_u32 s62, s62, s69
  s_and_b32 s64, s52, 3
  s_cmp_eq_u32 s64, s3
  s_cbranch_scc1 L_nopc
  buffer_store_dwordx4 v[40:43], v3, s[40:43], s62 offen sc1
L_nopc:
  s_mul_i32 s62, s52, 512
  s_add_u32 s62, s62, s69
  s_add_u32 s62, s62, 8192
  s_mov_b32 exec_hi, 0
  buffer_store_dwordx4 v[40:43], v3, s[40:43], s62 offen sc1
  s_cmp_lg_u32 s52, 0
  s_cbranch_scc1 L_nohc
  s_cmp_eq_u32 s101, 99
  s_cbranch_scc1 L_nohc
  s_lshl_b32 s62, s101, 7
  s_add_u32 s62, s62, 3178496
  v_lshlrev_b32 v7, 11, v11
  s_mov_b32 exec_lo, 0xffff
  buffer_store_dwordx4 v[40:43], v7, s[40:43], s62 offen sc1
  s_mov_b32 exec_lo, -1
L_nohc:
  s_mov_b32 exec_hi, -1
  s_add_u32 s64, s66, 0x2000
  buffer_load_dwordx4 v[76:79], v5, s[28:31], s64 offen nt
  s_mov_b32 s58, 0x05040100
  s_mov_b32 s59, 0x07060302
  v_lshrrev_b32 v0, 5, v11
  v_lshlrev_b32 v0, 11, v0
  v_and_b32 v2, 7, v11
  v_lshl_add_u32 v0, v2, 4, v0
  v_bfe_u32 v2, v11, 3, 1
  v_lshl_add_u32 v0, v2, 13, v0
  v_bfe_u32 v2, v11, 4, 1
  v_lshl_add_u32 v0, v2, 18, v0
  s_lshl_b32 s80, s3, 3
  s_add_u32 s80, s80, s52
  s_lshl_b32 s80, s80, 18
  s_lshl_b32 s81, s55, 8
  s_add_u32 s78, s80, s81
  s_and_b32 s81, s52, 1
  s_mul_i32 s81, s81, 258048
  s_sub_u32 s78, s78, s81
  s_and_b32 s81, s54, 1
  s_lshl_b32 s81, s81, 7
  s_add_u32 s78, s78, s81
  s_mul_i32 s68, s52, 11264
  s_add_u32 s68, s68, 65536
  s_mov_b32 s73, 2
  s_mov_b32 s60, 0x3e0293ee
  s_mov_b32 s70, 0x00ff00ff
  s_mov_b32 s71, 0x00ff00ff
  s_mov_b32 s72, 0
  s_and_b32 s100, s53, 3
  s_cmp_eq_u32 s100, 1
  s_cselect_b32 s100, -1, 0
  s_mov_b32 s24, s8
  s_mov_b32 s25, s9
  s_mov_b32 s26, 0x10000000
  s_mov_b32 s27, 0x00020000
  s_waitcnt vmcnt(5)
  buffer_load_dwordx4 v[140:143], v1, s[20:23], s63 offen offset:128 nt
  s_waitcnt vmcnt(5)
  s_add_u32 s64, s66, 0x4000
  buffer_load_dwordx4 v[80:83], v5, s[28:31], s64 offen nt
  s_add_u32 s63, s57, s97
  s_waitcnt vmcnt(5)
  buffer_load_dwordx4 v[144:147], v1, s[20:23], s63 offen offset:0 nt
  s_waitcnt vmcnt(5)
  s_add_u32 s64, s66, 0x6000
  buffer_load_dwordx4 v[84:87], v5, s[28:31], s64 offen nt
  s_waitcnt vmcnt(5)
  buffer_load_dwordx4 v[148:151], v1, s[20:23], s63 offen offset:128 nt
  s_mov_b32 s36, s12
  s_mov_b32 s37, s13
  s_mov_b32 s38, 0x800000
  s_mov_b32 s39, 0x00020000
  s_mov_b32 s44, s14
  s_mov_b32 s45, s15
  s_mov_b32 s46, 0x40000
  s_mov_b32 s47, 0x00020000
  s_mov_b32 s48, s16
  s_mov_b32 s49, s17
  s_mov_b32 s50, 0x100
  s_mov_b32 s51, 0x00020000
  s_waitcnt vmcnt(5)
  s_add_u32 s64, s66, 0x8000
  buffer_load_dwordx4 v[88:91], v5, s[28:31], s64 offen nt
  s_add_u32 s63, s57, s98
  s_waitcnt vmcnt(5)
  buffer_load_dwordx4 v[152:155], v1, s[20:23], s63 offen offset:0 nt
  s_waitcnt vmcnt(5)
  s_add_u32 s64, s66, 0xa000
  buffer_load_dwordx4 v[92:95], v5, s[28:31], s64 offen nt
  s_waitcnt vmcnt(5)
  buffer_load_dwordx4 v[156:159], v1, s[20:23], s63 offen offset:128 nt
  s_waitcnt vmcnt(5)
  s_add_u32 s64, s66, 0xc000
  buffer_load_dwordx4 v[96:99], v5, s[28:31], s64 offen nt
  s_add_u32 s63, s57, s99
  s_waitcnt vmcnt(5)
  buffer_load_dwordx4 v[160:163], v1, s[20:23], s63 offen offset:0 nt
  s_waitcnt vmcnt(5)
  s_add_u32 s64, s66, 0xe000
  buffer_load_dwordx4 v[100:103], v5, s[28:31], s64 offen nt
  s_waitcnt vmcnt(5)
  buffer_load_dwordx4 v[164:167], v1, s[20:23], s63 offen offset:128 nt
  s_cmp_lg_u32 s52, 0
  s_cbranch_scc1 L_nohs
  s_cmp_eq_u32 s101, 99
  s_cbranch_scc1 L_nohs
  v_mov_b32 v7, 1
  s_mov_b64 exec, 1
  buffer_atomic_add v7, off, s[48:51], 0 offset:128 sc1
  s_mov_b64 exec, -1
L_nohs:
  s_waitcnt vmcnt(5)
  s_add_u32 s64, s66, 0x40000
  buffer_load_dwordx4 v[232:235], v5, s[28:31], s64 offen nt
  s_add_u32 s56, s56, 1
  s_and_b32 s57, s56, 8
  s_lshl_b32 s57, s57, 21
  s_add_u32 s57, s57, s74
  s_add_u32 s75, s75, 1
  s_bfe_u32 s64, s75, 0x10000
  s_lshl_b32 s64, s64, 10
  s_add_u32 s57, s57, s64
  s_bfe_u32 s64, s75, 0x10001
  s_lshl_b32 s64, s64, 18
  s_add_u32 s57, s57, s64
  s_bfe_u32 s64, s75, 0x10002
  s_lshl_b32 s64, s64, 14
  s_add_u32 s57, s57, s64
  s_add_u32 s63, s57, s96
  s_waitcnt vmcnt(5)
  buffer_load_dwordx4 v[104:107], v1, s[20:23], s63 offen offset:0 nt
  s_waitcnt vmcnt(5)
  s_add_u32 s64, s66, 0x42000
  buffer_load_dwordx4 v[236:239], v5, s[28:31], s64 offen nt
  s_waitcnt vmcnt(5)
  buffer_load_dwordx4 v[108:111], v1, s[20:23], s63 offen offset:128 nt
  s_waitcnt vmcnt(5)
  s_add_u32 s64, s66, 0x44000
  buffer_load_dwordx4 v[240:243], v5, s[28:31], s64 offen nt
  s_add_u32 s63, s57, s97
  s_waitcnt vmcnt(5)
  buffer_load_dwordx4 v[112:115], v1, s[20:23], s63 offen offset:0 nt
  s_waitcnt vmcnt(5)
  buffer_load_dwordx4 v[116:119], v1, s[20:23], s63 offen offset:128 nt
  s_waitcnt vmcnt(5)
  s_add_u32 s64, s66, 0x46000
  buffer_load_dwordx4 v[244:247], v5, s[28:31], s64 offen nt
  s_add_u32 s63, s57, s98
  s_waitcnt vmcnt(5)
  buffer_load_dwordx4 v[120:123], v1, s[20:23], s63 offen offset:0 nt
  s_waitcnt vmcnt(5)
  s_add_u32 s64, s66, 0x48000
  buffer_load_dwordx4 v[248:251], v5, s[28:31], s64 offen nt
  s_waitcnt vmcnt(5)
  buffer_load_dwordx4 v[124:127], v1, s[20:23], s63 offen offset:128 nt
  s_waitcnt vmcnt(5)
  s_add_u32 s64, s66, 0x4a000
  buffer_load_dwordx4 v[12:15], v5, s[28:31], s64 offen nt
  s_add_u32 s63, s57, s99
  s_waitcnt vmcnt(5)
  buffer_load_dwordx4 v[128:131], v1, s[20:23], s63 offen offset:0 nt
  s_waitcnt vmcnt(5)
  s_add_u32 s64, s66, 0x4c000
  buffer_load_dwordx4 v[16:19], v5, s[28:31], s64 offen nt
  s_waitcnt vmcnt(5)
  buffer_load_dwordx4 v[132:135], v1, s[20:23], s63 offen offset:128 nt
  s_waitcnt vmcnt(5)
  s_add_u32 s64, s66, 0x4e000
  buffer_load_dwordx4 v[20:23], v5, s[28:31], s64 offen nt
  s_add_u32 s56, s56, 1
  s_and_b32 s57, s56, 8
  s_lshl_b32 s57, s57, 21
  s_add_u32 s57, s57, s74
  s_add_u32 s75, s75, 1
  s_bfe_u32 s64, s75, 0x10000
  s_lshl_b32 s64, s64, 10
  s_add_u32 s57, s57, s64
  s_bfe_u32 s64, s75, 0x10001
  s_lshl_b32 s64, s64, 18
  s_add_u32 s57, s57, s64
  s_bfe_u32 s64, s75, 0x10002
  s_lshl_b32 s64, s64, 14
  s_add_u32 s57, s57, s64
  s_add_u32 s63, s57, s96
  s_waitcnt vmcnt(5)
  buffer_load_dwordx4 v[168:171], v1, s[20:23], s63 offen offset:0 nt
  v_perm_b32 v24, v76, v72, s58
  v_perm_b32 v25, v84, v80, s58
  v_perm_b32 v26, v92, v88, s58
  v_perm_b32 v27, v100, v96, s58
  v_perm_b32 v28, v76, v72, s59
  v_perm_b32 v29, v84, v80, s59
  v_perm_b32 v30, v92, v88, s59
  v_perm_b32 v31, v100, v96, s59
  v_mfma_f32_16x16x32_bf16 v[40:43], v[24:27], v[32:35], 0
  v_perm_b32 v24, v77, v73, s58
  v_perm_b32 v25, v85, v81, s58
  v_perm_b32 v26, v93, v89, s58
  v_perm_b32 v27, v101, v97, s58
  v_mfma_f32_16x16x32_bf16 v[44:47], v[28:31], v[32:35], 0
  v_perm_b32 v28, v77, v73, s59
  v_perm_b32 v29, v85, v81, s59
  v_perm_b32 v30, v93, v89, s59
  v_perm_b32 v31, v101, v97, s59
  v_mfma_f32_16x16x32_bf16 v[48:51], v[24:27], v[32:35], 0
  v_perm_b32 v24, v78, v74, s58
  v_perm_b32 v25, v86, v82, s58
  v_perm_b32 v26, v94, v90, s58
  v_perm_b32 v27, v102, v98, s58
  v_mfma_f32_16x16x32_bf16 v[52:55], v[28:31], v[32:35], 0
  v_perm_b32 v28, v78, v74, s59
  v_perm_b32 v29, v86, v82, s59
  v_perm_b32 v30, v94, v90, s59
  v_perm_b32 v31, v102, v98, s59
  v_mfma_f32_16x16x32_bf16 v[56:59], v[24:27], v[32:35], 0
  v_perm_b32 v24, v79, v75, s58
  v_perm_b32 v25, v87, v83, s58
  v_perm_b32 v26, v95, v91, s58
  v_perm_b32 v27, v103, v99, s58
  v_mfma_f32_16x16x32_bf16 v[60:63], v[28:31], v[32:35], 0
  v_perm_b32 v28, v79, v75, s59
  v_perm_b32 v29, v87, v83, s59
  v_perm_b32 v30, v95, v91, s59
  v_perm_b32 v31, v103, v99, s59
  v_mfma_f32_16x16x32_bf16 v[64:67], v[24:27], v[32:35], 0
  s_nop 1
  v_mfma_f32_16x16x32_bf16 v[68:71], v[28:31], v[32:35], 0
  buffer_load_dwordx4 v[32:35], v6, s[32:35], s65 offen offset:128
  s_waitcnt vmcnt(5)
  s_add_u32 s64, s66, 0x80000
  buffer_load_dwordx4 v[72:75], v5, s[28:31], s64 offen nt
  s_waitcnt vmcnt(5)
  buffer_load_dwordx4 v[172:175], v1, s[20:23], s63 offen offset:128 nt
  s_waitcnt vmcnt(5)
  s_add_u32 s64, s66, 0x82000
  buffer_load_dwordx4 v[76:79], v5, s[28:31], s64 offen nt
  s_add_u32 s63, s57, s97
  s_waitcnt vmcnt(5)
  buffer_load_dwordx4 v[176:179], v1, s[20:23], s63 offen offset:0 nt
  s_waitcnt vmcnt(5)
  s_add_u32 s64, s66, 0x84000
  buffer_load_dwordx4 v[80:83], v5, s[28:31], s64 offen nt
  s_waitcnt vmcnt(5)
  buffer_load_dwordx4 v[180:183], v1, s[20:23], s63 offen offset:128 nt
  s_waitcnt vmcnt(5)
  s_add_u32 s64, s66, 0x86000
  buffer_load_dwordx4 v[84:87], v5, s[28:31], s64 offen nt
  s_add_u32 s63, s57, s98
  s_waitcnt vmcnt(5)
  buffer_load_dwordx4 v[184:187], v1, s[20:23], s63 offen offset:0 nt
  s_waitcnt vmcnt(5)
  s_add_u32 s64, s66, 0x88000
  buffer_load_dwordx4 v[88:91], v5, s[28:31], s64 offen nt
  s_waitcnt vmcnt(5)
  buffer_load_dwordx4 v[188:191], v1, s[20:23], s63 offen offset:128 nt
  s_waitcnt vmcnt(5)
  s_add_u32 s64, s66, 0x8a000
  buffer_load_dwordx4 v[92:95], v5, s[28:31], s64 offen nt
  s_add_u32 s63, s57, s99
  s_waitcnt vmcnt(5)
  buffer_load_dwordx4 v[192:195], v1, s[20:23], s63 offen offset:0 nt
  s_waitcnt vmcnt(5)
  buffer_load_dwordx4 v[196:199], v1, s[20:23], s63 offen offset:128 nt
  s_waitcnt vmcnt(5)
  s_add_u32 s64, s66, 0x8c000
  buffer_load_dwordx4 v[96:99], v5, s[28:31], s64 offen nt
  s_add_u32 s56, s56, 1
  s_and_b32 s57, s56, 8
  s_lshl_b32 s57, s57, 21
  s_add_u32 s57, s57, s74
  s_add_u32 s75, s75, 1
  s_bfe_u32 s64, s75, 0x10000
  s_lshl_b32 s64, s64, 10
  s_add_u32 s57, s57, s64
  s_bfe_u32 s64, s75, 0x10001
  s_lshl_b32 s64, s64, 18
  s_add_u32 s57, s57, s64
  s_bfe_u32 s64, s75, 0x10002
  s_lshl_b32 s64, s64, 14
  s_add_u32 s57, s57, s64
  s_add_u32 s63, s57, s96
  s_waitcnt vmcnt(5)
  buffer_load_dwordx4 v[200:203], v1, s[20:23], s63 offen offset:0 nt
  s_waitcnt vmcnt(5)
  s_add_u32 s64, s66, 0x8e000
  buffer_load_dwordx4 v[100:103], v5, s[28:31], s64 offen nt
  s_waitcnt vmcnt(5)
  buffer_load_dwordx4 v[204:207], v1, s[20:23], s63 offen offset:128 nt
  v_perm_b32 v24, v236, v232, s58
  v_perm_b32 v25, v244, v240, s58
  v_perm_b32 v26, v12, v248, s58
  v_perm_b32 v27, v20, v16, s58
  v_perm_b32 v28, v236, v232, s59
  v_perm_b32 v29, v244, v240, s59
  v_perm_b32 v30, v12, v248, s59
  v_perm_b32 v31, v20, v16, s59
  v_mfma_f32_16x16x32_bf16 v[40:43], v[24:27], v[36:39], v[40:43]
  v_perm_b32 v24, v237, v233, s58
  v_perm_b32 v25, v245, v241, s58
  v_perm_b32 v26, v13, v249, s58
  v_perm_b32 v27, v21, v17, s58
  v_mfma_f32_16x16x32_bf16 v[44:47], v[28:31], v[36:39], v[44:47]
  v_perm_b32 v28, v237, v233, s59
  v_perm_b32 v29, v245, v241, s59
  v_perm_b32 v30, v13, v249, s59
  v_perm_b32 v31, v21, v17, s59
  v_mfma_f32_16x16x32_bf16 v[48:51], v[24:27], v[36:39], v[48:51]
  v_perm_b32 v24, v238, v234, s58
  v_perm_b32 v25, v246, v242, s58
  v_perm_b32 v26, v14, v250, s58
  v_perm_b32 v27, v22, v18, s58
  v_mfma_f32_16x16x32_bf16 v[52:55], v[28:31], v[36:39], v[52:55]
  v_perm_b32 v28, v238, v234, s59
  v_perm_b32 v29, v246, v242, s59
  v_perm_b32 v30, v14, v250, s59
  v_perm_b32 v31, v22, v18, s59
  v_mfma_f32_16x16x32_bf16 v[56:59], v[24:27], v[36:39], v[56:59]
  v_perm_b32 v24, v239, v235, s58
  v_perm_b32 v25, v247, v243, s58
  v_perm_b32 v26, v15, v251, s58
  v_perm_b32 v27, v23, v19, s58
  v_mfma_f32_16x16x32_bf16 v[60:63], v[28:31], v[36:39], v[60:63]
  v_perm_b32 v28, v239, v235, s59
  v_perm_b32 v29, v247, v243, s59
  v_perm_b32 v30, v15, v251, s59
  v_perm_b32 v31, v23, v19, s59
  v_mfma_f32_16x16x32_bf16 v[64:67], v[24:27], v[36:39], v[64:67]
  s_nop 1
  v_mfma_f32_16x16x32_bf16 v[68:71], v[28:31], v[36:39], v[68:71]
  buffer_load_dwordx4 v[36:39], v6, s[32:35], s65 offen offset:192
  s_waitcnt vmcnt(5)
  s_add_u32 s64, s66, 0xc0000
  buffer_load_dwordx4 v[232:235], v5, s[28:31], s64 offen nt
  s_add_u32 s63, s57, s97
  s_waitcnt vmcnt(5)
  buffer_load_dwordx4 v[208:211], v1, s[20:23], s63 offen offset:0 nt
  s_waitcnt vmcnt(5)
  s_add_u32 s64, s66, 0xc2000
  buffer_load_dwordx4 v[236:239], v5, s[28:31], s64 offen nt
  s_waitcnt vmcnt(5)
  buffer_load_dwordx4 v[212:215], v1, s[20:23], s63 offen offset:128 nt
  s_waitcnt vmcnt(5)
  s_add_u32 s64, s66, 0xc4000
  buffer_load_dwordx4 v[240:243], v5, s[28:31], s64 offen nt
  s_add_u32 s63, s57, s98
  s_waitcnt vmcnt(5)
  buffer_load_dwordx4 v[216:219], v1, s[20:23], s63 offen offset:0 nt
  s_waitcnt vmcnt(5)
  s_add_u32 s64, s66, 0xc6000
  buffer_load_dwordx4 v[244:247], v5, s[28:31], s64 offen nt
  s_waitcnt vmcnt(5)
  buffer_load_dwordx4 v[220:223], v1, s[20:23], s63 offen offset:128 nt
  s_waitcnt vmcnt(5)
  s_add_u32 s64, s66, 0xc8000
  buffer_load_dwordx4 v[248:251], v5, s[28:31], s64 offen nt
  s_add_u32 s63, s57, s99
  s_waitcnt vmcnt(5)
  buffer_load_dwordx4 v[224:227], v1, s[20:23], s63 offen offset:0 nt
  s_waitcnt vmcnt(5)
  s_add_u32 s64, s66, 0xca000
  buffer_load_dwordx4 v[12:15], v5, s[28:31], s64 offen nt
  s_waitcnt vmcnt(5)
  buffer_load_dwordx4 v[228:231], v1, s[20:23], s63 offen offset:128 nt
  s_waitcnt vmcnt(5)
  s_add_u32 s64, s66, 0xcc000
  buffer_load_dwordx4 v[16:19], v5, s[28:31], s64 offen nt
  s_add_u32 s56, s56, 1
  s_and_b32 s57, s56, 8
  s_lshl_b32 s57, s57, 21
  s_add_u32 s57, s57, s74
  s_add_u32 s75, s75, 1
  s_bfe_u32 s64, s75, 0x10000
  s_lshl_b32 s64, s64, 10
  s_add_u32 s57, s57, s64
  s_bfe_u32 s64, s75, 0x10001
  s_lshl_b32 s64, s64, 18
  s_add_u32 s57, s57, s64
  s_bfe_u32 s64, s75, 0x10002
  s_lshl_b32 s64, s64, 14
  s_add_u32 s57, s57, s64
  s_add_u32 m0, s68, 0
  s_add_u32 s63, s57, s96
  s_waitcnt vmcnt(5)
  s_nop 0
  buffer_load_dwordx4 v1, s[20:23], s63 offen offset:0 nt lds
  s_waitcnt vmcnt(5)
  s_add_u32 s64, s66, 0xce000
  buffer_load_dwordx4 v[20:23], v5, s[28:31], s64 offen nt
  s_add_u32 m0, s68, 896
  s_waitcnt vmcnt(5)
  s_nop 0
  buffer_load_dwordx4 v1, s[20:23], s63 offen offset:128 nt lds
  s_add_u32 m0, s68, 2048
  s_add_u32 s63, s57, s97
  s_waitcnt vmcnt(5)
  s_nop 0
  buffer_load_dwordx4 v1, s[20:23], s63 offen offset:0 nt lds
  v_perm_b32 v24, v76, v72, s58
  v_perm_b32 v25, v84, v80, s58
  v_perm_b32 v26, v92, v88, s58
  v_perm_b32 v27, v100, v96, s58
  v_perm_b32 v28, v76, v72, s59
  v_perm_b32 v29, v84, v80, s59
  v_perm_b32 v30, v92, v88, s59
  v_perm_b32 v31, v100, v96, s59
  v_mfma_f32_16x16x32_bf16 v[40:43], v[24:27], v[32:35], v[40:43]
  v_perm_b32 v24, v77, v73, s58
  v_perm_b32 v25, v85, v81, s58
  v_perm_b32 v26, v93, v89, s58
  v_perm_b32 v27, v101, v97, s58
  v_mfma_f32_16x16x32_bf16 v[44:47], v[28:31], v[32:35], v[44:47]
  v_perm_b32 v28, v77, v73, s59
  v_perm_b32 v29, v85, v81, s59
  v_perm_b32 v30, v93, v89, s59
  v_perm_b32 v31, v101, v97, s59
  v_mfma_f32_16x16x32_bf16 v[48:51], v[24:27], v[32:35], v[48:51]
  v_perm_b32 v24, v78, v74, s58
  v_perm_b32 v25, v86, v82, s58
  v_perm_b32 v26, v94, v90, s58
  v_perm_b32 v27, v102, v98, s58
  v_mfma_f32_16x16x32_bf16 v[52:55], v[28:31], v[32:35], v[52:55]
  v_perm_b32 v28, v78, v74, s59
  v_perm_b32 v29, v86, v82, s59
  v_perm_b32 v30, v94, v90, s59
  v_perm_b32 v31, v102, v98, s59
  v_mfma_f32_16x16x32_bf16 v[56:59], v[24:27], v[32:35], v[56:59]
  v_perm_b32 v24, v79, v75, s58
  v_perm_b32 v25, v87, v83, s58
  v_perm_b32 v26, v95, v91, s58
  v_perm_b32 v27, v103, v99, s58
  v_mfma_f32_16x16x32_bf16 v[60:63], v[28:31], v[32:35], v[60:63]
  v_perm_b32 v28, v79, v75, s59
  v_perm_b32 v29, v87, v83, s59
  v_perm_b32 v30, v95, v91, s59
  v_perm_b32 v31, v103, v99, s59
  v_mfma_f32_16x16x32_bf16 v[64:67], v[24:27], v[32:35], v[64:67]
  s_nop 1
  v_mfma_f32_16x16x32_bf16 v[68:71], v[28:31], v[32:35], v[68:71]
  s_add_u32 m0, s68, 2944
  s_waitcnt vmcnt(5)
  s_nop 0
  buffer_load_dwordx4 v1, s[20:23], s63 offen offset:128 nt lds
  s_add_u32 m0, s68, 4096
  s_add_u32 s63, s57, s98
  s_waitcnt vmcnt(5)
  s_nop 0
  buffer_load_dwordx4 v1, s[20:23], s63 offen offset:0 nt lds
  s_add_u32 m0, s68, 4992
  s_waitcnt vmcnt(5)
  s_nop 0
  buffer_load_dwordx4 v1, s[20:23], s63 offen offset:128 nt lds
  s_add_u32 m0, s68, 6144
  s_add_u32 s63, s57, s99
  s_waitcnt vmcnt(5)
  s_nop 0
  buffer_load_dwordx4 v1, s[20:23], s63 offen offset:0 nt lds
  v_perm_b32 v24, v236, v232, s58
  v_perm_b32 v25, v244, v240, s58
  v_perm_b32 v26, v12, v248, s58
  v_perm_b32 v27, v20, v16, s58
  v_perm_b32 v28, v236, v232, s59
  v_perm_b32 v29, v244, v240, s59
  v_perm_b32 v30, v12, v248, s59
  v_perm_b32 v31, v20, v16, s59
  v_mfma_f32_16x16x32_bf16 v[40:43], v[24:27], v[36:39], v[40:43]
  v_perm_b32 v24, v237, v233, s58
  v_perm_b32 v25, v245, v241, s58
  v_perm_b32 v26, v13, v249, s58
  v_perm_b32 v27, v21, v17, s58
  v_mfma_f32_16x16x32_bf16 v[44:47], v[28:31], v[36:39], v[44:47]
  v_perm_b32 v28, v237, v233, s59
  v_perm_b32 v29, v245, v241, s59
  v_perm_b32 v30, v13, v249, s59
  v_perm_b32 v31, v21, v17, s59
  v_mfma_f32_16x16x32_bf16 v[48:51], v[24:27], v[36:39], v[48:51]
  v_perm_b32 v24, v238, v234, s58
  v_perm_b32 v25, v246, v242, s58
  v_perm_b32 v26, v14, v250, s58
  v_perm_b32 v27, v22, v18, s58
  v_mfma_f32_16x16x32_bf16 v[52:55], v[28:31], v[36:39], v[52:55]
  v_perm_b32 v28, v238, v234, s59
  v_perm_b32 v29, v246, v242, s59
  v_perm_b32 v30, v14, v250, s59
  v_perm_b32 v31, v22, v18, s59
  v_mfma_f32_16x16x32_bf16 v[56:59], v[24:27], v[36:39], v[56:59]
  v_perm_b32 v24, v239, v235, s58
  v_perm_b32 v25, v247, v243, s58
  v_perm_b32 v26, v15, v251, s58
  v_perm_b32 v27, v23, v19, s58
  v_mfma_f32_16x16x32_bf16 v[60:63], v[28:31], v[36:39], v[60:63]
  v_perm_b32 v28, v239, v235, s59
  v_perm_b32 v29, v247, v243, s59
  v_perm_b32 v30, v15, v251, s59
  v_perm_b32 v31, v23, v19, s59
  v_mfma_f32_16x16x32_bf16 v[64:67], v[24:27], v[36:39], v[64:67]
  s_nop 1
  v_mfma_f32_16x16x32_bf16 v[68:71], v[28:31], v[36:39], v[68:71]
  s_add_u32 m0, s68, 7040
  s_nop 0
  buffer_load_dwordx4 v1, s[20:23], s63 offen offset:128 nt lds
  s_add_u32 s56, s56, 1
  s_and_b32 s57, s56, 8
  s_lshl_b32 s57, s57, 21
  s_add_u32 s57, s57, s74
  s_add_u32 s75, s75, 1
  s_bfe_u32 s64, s75, 0x10000
  s_lshl_b32 s64, s64, 10
  s_add_u32 s57, s57, s64
  s_bfe_u32 s64, s75, 0x10001
  s_lshl_b32 s64, s64, 18
  s_add_u32 s57, s57, s64
  s_bfe_u32 s64, s75, 0x10002
  s_lshl_b32 s64, s64, 14
  s_add_u32 s57, s57, s64
  s_add_u32 m0, s68, 8192
  s_add_u32 s63, s57, s96
  s_nop 0
  buffer_load_dwordx4 v1, s[20:23], s63 offen offset:0 nt lds
  s_add_u32 m0, s68, 9088
  s_nop 0
  buffer_load_dwordx4 v1, s[20:23], s63 offen offset:128 nt lds
  s_add_u32 m0, s68, 10240
  s_add_u32 s63, s57, s97
  s_nop 0
  buffer_load_dwordx4 v1, s[20:23], s63 offen offset:0 nt lds
  s_lshl_b32 s61, s52, 13
  v_add_u32 v16, s61, v3
  v_mov_b32 v8, 0
  v_mov_b32 v9, 0
  v_mov_b32 v10, 161024
  ds_write_b64 v10, v[8:9]
  s_nop 4
  ds_write_b128 v16, v[40:43] offset:0
  ds_write_b128 v16, v[44:47] offset:1024
  ds_write_b128 v16, v[48:51] offset:2048
  ds_write_b128 v16, v[52:55] offset:3072
  ds_write_b128 v16, v[56:59] offset:4096
  ds_write_b128 v16, v[60:63] offset:5120
  ds_write_b128 v16, v[64:67] offset:6144
  ds_write_b128 v16, v[68:71] offset:7168
  s_lshl_b32 s61, s52, 10
  v_add_u32 v16, s61, v3
  s_waitcnt lgkmcnt(0)
  s_barrier
  ds_read_b128 v[40:43], v16 offset:0
  ds_read_b128 v[44:47], v16 offset:8192
  ds_read_b128 v[48:51], v16 offset:16384
  ds_read_b128 v[52:55], v16 offset:24576
  ds_read_b128 v[56:59], v16 offset:32768
  ds_read_b128 v[60:63], v16 offset:40960
  ds_read_b128 v[64:67], v16 offset:49152
  ds_read_b128 v[68:71], v16 offset:57344
  v_and_b32 v8, 15, v11
  v_lshrrev_b32 v9, 4, v11
  v_mul_u32_u24 v17, 272, v8
  v_lshl_add_u32 v17, v9, 6, v17
  s_lshl_b32 s61, s52, 1
  s_add_u32 s61, s61, 155648
  v_add_u32 v17, s61, v17
  s_waitcnt lgkmcnt(0)
  v_add_f32 v40, v40, v56
  v_add_f32 v41, v41, v57
  v_add_f32 v42, v42, v58
  v_add_f32 v43, v43, v59
  v_add_f32 v44, v44, v60
  v_add_f32 v45, v45, v61
  v_add_f32 v46, v46, v62
  v_add_f32 v47, v47, v63
  v_add_f32 v48, v48, v64
  v_add_f32 v49, v49, v65
  v_add_f32 v50, v50, v66
  v_add_f32 v51, v51, v67
  v_add_f32 v52, v52, v68
  v_add_f32 v53, v53, v69
  v_add_f32 v54, v54, v70
  v_add_f32 v55, v55, v71
  v_add_f32 v40, v40, v48
  v_add_f32 v41, v41, v49
  v_add_f32 v42, v42, v50
  v_add_f32 v43, v43, v51
  v_add_f32 v44, v44, v52
  v_add_f32 v45, v45, v53
  v_add_f32 v46, v46, v54
  v_add_f32 v47, v47, v55
  v_add_f32 v40, v40, v44
  v_add_f32 v41, v41, v45
  v_add_f32 v42, v42, v46
  v_add_f32 v43, v43, v47
  v_cvt_pk_bf16_f32 v44, v40, v41
  v_cvt_pk_bf16_f32 v45, v42, v43
  ds_write_b16 v17, v44 offset:0
  ds_write_b16_d16_hi v17, v44 offset:16
  ds_write_b16 v17, v45 offset:32
  ds_write_b16_d16_hi v17, v45 offset:48
  s_waitcnt lgkmcnt(0)
  s_barrier
  v_and_b32 v8, 7, v11
  v_lshrrev_b32 v9, 3, v11
  v_mul_u32_u24 v8, 272, v8
  v_lshl_add_u32 v8, v9, 4, v8
  s_mul_i32 s61, s72, 2176
  s_add_u32 s61, s61, 155648
  v_add_u32 v8, s61, v8
  ds_read_b128 v[32:35], v8 offset:0
  ds_read_b128 v[36:39], v8 offset:128
  v_mov_b32 v5, 0xff7fffff
  v_mov_b32 v6, 0
  v_lshrrev_b32 v9, 4, v11
  v_and_b32 v8, 7, v11
  v_lshlrev_b32 v9, 7, v9
  v_lshl_add_u32 v9, v8, 4, v9
  s_lshl_b32 s61, s52, 12
  v_add_u32 v40, s61, v9
  s_mov_b64 s[0:1], 0xff
  v_mov_b32 v253, 0
  v_mov_b32 v2, v1
  v_add_u32 v4, 128, v1
  s_mul_i32 s29, s54, 397312
  s_mov_b32 s30, 0
  s_add_u32 s4, s57, s96
  s_add_u32 s5, s57, s97
  s_add_u32 s6, s57, s98
  s_add_u32 s7, s57, s99
  s_mov_b32 s11, s100
  s_mov_b32 s10, 0
  s_mov_b32 s12, 0
  s_mov_b32 s33, 0
  s_mov_b32 s13, 0
  s_cmp_eq_u32 s101, 99
  s_cselect_b32 s15, 99, s52
  s_lshl_b32 s35, s101, 7
  s_add_u32 s35, s35, 3178496
  s_lshl_b32 s34, s3, 3
  s_add_u32 s34, s34, s52
  s_mul_i32 s34, s34, 12416
  s_add_u32 s34, s34, s29
  s_add_u32 s34, s34, 8192
  s_and_b32 s61, s52, 1
  s_mul_i32 s61, s61, 12288
  s_sub_u32 s34, s34, s61
  s_and_b32 s61, s54, 1
  s_mul_i32 s61, s61, 397312
  s_sub_u32 s34, s34, s61
  v_add_u32 v252, s68, v3
  s_waitcnt lgkmcnt(0)
  v_mfma_f32_32x32x16_bf16 v[72:87], v[136:139], v[32:35], 0
  v_mfma_f32_32x32x16_bf16 v[72:87], v[140:143], v[36:39], v[72:87]
  v_mfma_f32_32x32x16_bf16 v[88:103], v[144:147], v[32:35], 0
  v_mfma_f32_32x32x16_bf16 v[88:103], v[148:151], v[36:39], v[88:103]
  s_nop 9
  v_add_f32_dpp v72, v73, v72 row_ror:8 row_mask:0x5 bank_mask:0xf
  v_add_f32_dpp v72, v75, v74 row_ror:8 row_mask:0xa bank_mask:0xf
  v_add_f32_dpp v76, v77, v76 row_ror:8 row_mask:0x5 bank_mask:0xf
  v_add_f32_dpp v76, v79, v78 row_ror:8 row_mask:0xa bank_mask:0xf
  v_add_f32_dpp v80, v81, v80 row_ror:8 row_mask:0x5 bank_mask:0xf
  v_add_f32_dpp v80, v83, v82 row_ror:8 row_mask:0xa bank_mask:0xf
  v_add_f32_dpp v84, v85, v84 row_ror:8 row_mask:0x5 bank_mask:0xf
  v_add_f32_dpp v84, v87, v86 row_ror:8 row_mask:0xa bank_mask:0xf
  s_nop 1
  v_permlane16_swap_b32 v72, v76
  v_permlane16_swap_b32 v80, v84
  v_add_f32 v16, v72, v76
  v_add_f32 v17, v80, v84
  v_mfma_f32_32x32x16_bf16 v[72:87], v[152:155], v[32:35], 0
  v_mfma_f32_32x32x16_bf16 v[72:87], v[156:159], v[36:39], v[72:87]
  v_add_f32_dpp v88, v89, v88 row_ror:8 row_mask:0x5 bank_mask:0xf
  v_add_f32_dpp v88, v91, v90 row_ror:8 row_mask:0xa bank_mask:0xf
  v_add_f32_dpp v92, v93, v92 row_ror:8 row_mask:0x5 bank_mask:0xf
  v_add_f32_dpp v92, v95, v94 row_ror:8 row_mask:0xa bank_mask:0xf
  v_add_f32_dpp v96, v97, v96 row_ror:8 row_mask:0x5 bank_mask:0xf
  v_add_f32_dpp v96, v99, v98 row_ror:8 row_mask:0xa bank_mask:0xf
  v_add_f32_dpp v100, v101, v100 row_ror:8 row_mask:0x5 bank_mask:0xf
  v_add_f32_dpp v100, v103, v102 row_ror:8 row_mask:0xa bank_mask:0xf
  s_nop 1
  v_permlane16_swap_b32 v88, v92
  v_permlane16_swap_b32 v96, v100
  v_add_f32 v18, v88, v92
  v_add_f32 v19, v96, v100
  v_mfma_f32_32x32x16_bf16 v[88:103], v[160:163], v[32:35], 0
  v_mfma_f32_32x32x16_bf16 v[88:103], v[164:167], v[36:39], v[88:103]
  v_add_f32_dpp v72, v73, v72 row_ror:8 row_mask:0x5 bank_mask:0xf
  v_add_f32_dpp v72, v75, v74 row_ror:8 row_mask:0xa bank_mask:0xf
  v_add_f32_dpp v76, v77, v76 row_ror:8 row_mask:0x5 bank_mask:0xf
  v_add_f32_dpp v76, v79, v78 row_ror:8 row_mask:0xa bank_mask:0xf
  v_add_f32_dpp v80, v81, v80 row_ror:8 row_mask:0x5 bank_mask:0xf
  v_add_f32_dpp v80, v83, v82 row_ror:8 row_mask:0xa bank_mask:0xf
  v_add_f32_dpp v84, v85, v84 row_ror:8 row_mask:0x5 bank_mask:0xf
  v_add_f32_dpp v84, v87, v86 row_ror:8 row_mask:0xa bank_mask:0xf
  s_nop 1
  v_permlane16_swap_b32 v72, v76
  v_permlane16_swap_b32 v80, v84
  v_add_f32 v20, v72, v76
  v_add_f32 v21, v80, v84
  v_add_f32_dpp v88, v89, v88 row_ror:8 row_mask:0x5 bank_mask:0xf
  v_add_f32_dpp v88, v91, v90 row_ror:8 row_mask:0xa bank_mask:0xf
  v_add_f32_dpp v92, v93, v92 row_ror:8 row_mask:0x5 bank_mask:0xf
  v_add_f32_dpp v92, v95, v94 row_ror:8 row_mask:0xa bank_mask:0xf
  v_add_f32_dpp v96, v97, v96 row_ror:8 row_mask:0x5 bank_mask:0xf
  v_add_f32_dpp v96, v99, v98 row_ror:8 row_mask:0xa bank_mask:0xf
  v_add_f32_dpp v100, v101, v100 row_ror:8 row_mask:0x5 bank_mask:0xf
  v_add_f32_dpp v100, v103, v102 row_ror:8 row_mask:0xa bank_mask:0xf
  s_nop 1
  v_permlane16_swap_b32 v88, v92
  v_permlane16_swap_b32 v96, v100
  v_add_f32 v22, v88, v92
  v_add_f32 v23, v96, v100
  buffer_load_dwordx4 v[148:151], v1, s[20:23], s5 offen offset:128 nt
  buffer_load_dwordx4 v[152:155], v1, s[20:23], s6 offen offset:0 nt
  buffer_load_dwordx4 v[156:159], v1, s[20:23], s6 offen offset:128 nt
  s_cmp_lg_u32 s52, 7
  s_cbranch_scc1 L_t1
  s_getreg_b32 s63, hwreg(HW_REG_XCC_ID, 0, 4)
  s_sub_u32 s63, s63, s2
  s_and_b32 s63, s63, 7
  s_mul_i32 s64, s63, s63
  s_lshl_b32 s64, s64, 8
  s_add_u32 s64, s64, s63
  s_lshl_b32 s64, s64, 6
  s_add_u32 s64, s64, 1
  v_mov_b32 v8, s64
  s_lshl_b32 s63, s54, 4
  s_mov_b64 exec, 1
  buffer_atomic_add v8, off, s[48:51], s63 sc1
  s_mov_b64 exec, -1
L_t1:
  v_max3_f32 v8, v16, v17, v18
  v_max3_f32 v9, v19, v20, v21
  v_max3_f32 v8, v8, v22, v23
  v_max_f32 v8, v8, v9
  v_mov_b32 v9, v8
  s_nop 1
  v_permlane16_swap_b32 v9, v8
  v_max_f32 v8, v8, v9
  v_mov_b32 v9, v8
  s_nop 1
  v_permlane32_swap_b32 v9, v8
  v_max_f32 v8, v8, v9
  v_mul_f32 v8, s60, v8
  v_max_f32 v10, v5, v8
  v_sub_f32 v9, v5, v10
  v_exp_f32 v7, v9
  v_mov_b32 v5, v10
  v_fma_f32 v16, v16, s60, -v10
  v_fma_f32 v17, v17, s60, -v10
  v_fma_f32 v18, v18, s60, -v10
  v_fma_f32 v19, v19, s60, -v10
  v_fma_f32 v20, v20, s60, -v10
  v_fma_f32 v21, v21, s60, -v10
  v_fma_f32 v22, v22, s60, -v10
  v_fma_f32 v23, v23, s60, -v10
  v_exp_f32 v16, v16
  v_exp_f32 v17, v17
  v_exp_f32 v18, v18
  v_exp_f32 v19, v19
  v_exp_f32 v20, v20
  v_exp_f32 v21, v21
  v_exp_f32 v22, v22
  v_exp_f32 v23, v23
  v_mul_f32 v6, v6, v7
  v_cvt_pk_bf16_f32 v12, v16, v17
  v_cvt_pk_bf16_f32 v13, v18, v19
  v_cvt_pk_bf16_f32 v14, v20, v21
  v_cvt_pk_bf16_f32 v15, v22, v23
  v_add_f32 v8, v16, v17
  v_add_f32 v9, v18, v19
  v_add_f32 v20, v20, v21
  v_add_f32 v22, v22, v23
  v_add_f32 v8, v8, v9
  v_add_f32 v20, v20, v22
  v_add_f32 v6, v6, v8
  v_add_f32 v6, v6, v20
  v_mov_b32_dpp v7, v7 row_ror:8 row_mask:0xf bank_mask:0xc
  s_mov_b64 exec, s[70:71]
  ds_write_b128 v40, v[12:15]
  s_mov_b64 exec, -1
  v_cndmask_b32 v253, v253, v7, s[0:1]
  s_lshl_b64 s[0:1], s[0:1], 8
  v_add_u32 v40, 512, v40
  buffer_load_dwordx4 v[160:163], v1, s[20:23], s7 offen offset:0 nt
  buffer_load_dwordx4 v[164:167], v1, s[20:23], s7 offen offset:128 nt
  v_mfma_f32_32x32x16_bf16 v[72:87], v[104:107], v[32:35], 0
  v_mfma_f32_32x32x16_bf16 v[72:87], v[108:111], v[36:39], v[72:87]
  v_mfma_f32_32x32x16_bf16 v[88:103], v[112:115], v[32:35], 0
  v_mfma_f32_32x32x16_bf16 v[88:103], v[116:119], v[36:39], v[88:103]
  s_nop 9
  v_add_f32_dpp v72, v73, v72 row_ror:8 row_mask:0x5 bank_mask:0xf
  v_add_f32_dpp v72, v75, v74 row_ror:8 row_mask:0xa bank_mask:0xf
  v_add_f32_dpp v76, v77, v76 row_ror:8 row_mask:0x5 bank_mask:0xf
  v_add_f32_dpp v76, v79, v78 row_ror:8 row_mask:0xa bank_mask:0xf
  v_add_f32_dpp v80, v81, v80 row_ror:8 row_mask:0x5 bank_mask:0xf
  v_add_f32_dpp v80, v83, v82 row_ror:8 row_mask:0xa bank_mask:0xf
  v_add_f32_dpp v84, v85, v84 row_ror:8 row_mask:0x5 bank_mask:0xf
  v_add_f32_dpp v84, v87, v86 row_ror:8 row_mask:0xa bank_mask:0xf
  s_nop 1
  v_permlane16_swap_b32 v72, v76
  v_permlane16_swap_b32 v80, v84
  v_add_f32 v16, v72, v76
  v_add_f32 v17, v80, v84
  v_mfma_f32_32x32x16_bf16 v[72:87], v[120:123], v[32:35], 0
  v_mfma_f32_32x32x16_bf16 v[72:87], v[124:127], v[36:39], v[72:87]
  v_add_f32_dpp v88, v89, v88 row_ror:8 row_mask:0x5 bank_mask:0xf
  v_add_f32_dpp v88, v91, v90 row_ror:8 row_mask:0xa bank_mask:0xf
  v_add_f32_dpp v92, v93, v92 row_ror:8 row_mask:0x5 bank_mask:0xf
  v_add_f32_dpp v92, v95, v94 row_ror:8 row_mask:0xa bank_mask:0xf
  v_add_f32_dpp v96, v97, v96 row_ror:8 row_mask:0x5 bank_mask:0xf
  v_add_f32_dpp v96, v99, v98 row_ror:8 row_mask:0xa bank_mask:0xf
  v_add_f32_dpp v100, v101, v100 row_ror:8 row_mask:0x5 bank_mask:0xf
  v_add_f32_dpp v100, v103, v102 row_ror:8 row_mask:0xa bank_mask:0xf
  s_nop 1
  v_permlane16_swap_b32 v88, v92
  v_permlane16_swap_b32 v96, v100
  v_add_f32 v18, v88, v92
  v_add_f32 v19, v96, v100
  v_mfma_f32_32x32x16_bf16 v[88:103], v[128:131], v[32:35], 0
  v_mfma_f32_32x32x16_bf16 v[88:103], v[132:135], v[36:39], v[88:103]
  v_add_f32_dpp v72, v73, v72 row_ror:8 row_mask:0x5 bank_mask:0xf
  v_add_f32_dpp v72, v75, v74 row_ror:8 row_mask:0xa bank_mask:0xf
  v_add_f32_dpp v76, v77, v76 row_ror:8 row_mask:0x5 bank_mask:0xf
  v_add_f32_dpp v76, v79, v78 row_ror:8 row_mask:0xa bank_mask:0xf
  v_add_f32_dpp v80, v81, v80 row_ror:8 row_mask:0x5 bank_mask:0xf
  v_add_f32_dpp v80, v83, v82 row_ror:8 row_mask:0xa bank_mask:0xf
  v_add_f32_dpp v84, v85, v84 row_ror:8 row_mask:0x5 bank_mask:0xf
  v_add_f32_dpp v84, v87, v86 row_ror:8 row_mask:0xa bank_mask:0xf
  s_nop 1
  v_permlane16_swap_b32 v72, v76
  v_permlane16_swap_b32 v80, v84
  v_add_f32 v20, v72, v76
  v_add_f32 v21, v80, v84
  v_add_f32_dpp v88, v89, v88 row_ror:8 row_mask:0x5 bank_mask:0xf
  v_add_f32_dpp v88, v91, v90 row_ror:8 row_mask:0xa bank_mask:0xf
  v_add_f32_dpp v92, v93, v92 row_ror:8 row_mask:0x5 bank_mask:0xf
  v_add_f32_dpp v92, v95, v94 row_ror:8 row_mask:0xa bank_mask:0xf
  v_add_f32_dpp v96, v97, v96 row_ror:8 row_mask:0x5 bank_mask:0xf
  v_add_f32_dpp v96, v99, v98 row_ror:8 row_mask:0xa bank_mask:0xf
  v_add_f32_dpp v100, v101, v100 row_ror:8 row_mask:0x5 bank_mask:0xf
  v_add_f32_dpp v100, v103, v102 row_ror:8 row_mask:0xa bank_mask:0xf
  s_nop 1
  v_permlane16_swap_b32 v88, v92
  v_permlane16_swap_b32 v96, v100
  v_add_f32 v22, v88, v92
  v_add_f32 v23, v96, v100
  s_add_u32 s56, s56, 1
  s_and_b32 s57, s56, 8
  s_lshl_b32 s57, s57, 21
  s_add_u32 s57, s57, s74
  s_add_u32 s75, s75, 1
  s_bfe_u32 s64, s75, 0x10000
  s_lshl_b32 s64, s64, 10
  s_add_u32 s57, s57, s64
  s_bfe_u32 s64, s75, 0x10001
  s_lshl_b32 s64, s64, 18
  s_add_u32 s57, s57, s64
  s_bfe_u32 s64, s75, 0x10002
  s_lshl_b32 s64, s64, 14
  s_add_u32 s57, s57, s64
  s_add_u32 s4, s57, s96
  s_add_u32 s5, s57, s97
  s_add_u32 s6, s57, s98
  s_add_u32 s7, s57, s99
  buffer_load_dwordx4 v[104:107], v1, s[20:23], s4 offen offset:0 nt
  buffer_load_dwordx4 v[108:111], v1, s[20:23], s4 offen offset:128 nt
  v_max3_f32 v8, v16, v17, v18
  v_max3_f32 v9, v19, v20, v21
  v_max3_f32 v8, v8, v22, v23
  v_max_f32 v8, v8, v9
  v_mov_b32 v9, v8
  s_nop 1
  v_permlane16_swap_b32 v9, v8
  v_max_f32 v8, v8, v9
  v_mov_b32 v9, v8
  s_nop 1
  v_permlane32_swap_b32 v9, v8
  v_max_f32 v8, v8, v9
  v_mul_f32 v8, s60, v8
  v_max_f32 v10, v5, v8
  v_sub_f32 v9, v5, v10
  v_exp_f32 v7, v9
  v_mov_b32 v5, v10
  v_fma_f32 v16, v16, s60, -v10
  v_fma_f32 v17, v17, s60, -v10
  v_fma_f32 v18, v18, s60, -v10
  v_fma_f32 v19, v19, s60, -v10
  v_fma_f32 v20, v20, s60, -v10
  v_fma_f32 v21, v21, s60, -v10
  v_fma_f32 v22, v22, s60, -v10
  v_fma_f32 v23, v23, s60, -v10
  v_exp_f32 v16, v16
  v_exp_f32 v17, v17
  v_exp_f32 v18, v18
  v_exp_f32 v19, v19
  v_exp_f32 v20, v20
  v_exp_f32 v21, v21
  v_exp_f32 v22, v22
  v_exp_f32 v23, v23
  v_mul_f32 v6, v6, v7
  v_cvt_pk_bf16_f32 v12, v16, v17
  v_cvt_pk_bf16_f32 v13, v18, v19
  v_cvt_pk_bf16_f32 v14, v20, v21
  v_cvt_pk_bf16_f32 v15, v22, v23
  v_add_f32 v8, v16, v17
  v_add_f32 v9, v18, v19
  v_add_f32 v20, v20, v21
  v_add_f32 v22, v22, v23
  v_add_f32 v8, v8, v9
  v_add_f32 v20, v20, v22
  v_add_f32 v6, v6, v8
  v_add_f32 v6, v6, v20
  v_mov_b32_dpp v7, v7 row_ror:8 row_mask:0xf bank_mask:0xc
  s_mov_b64 exec, s[70:71]
  ds_write_b128 v40, v[12:15]
  s_mov_b64 exec, -1
  v_cndmask_b32 v253, v253, v7, s[0:1]
  s_lshl_b64 s[0:1], s[0:1], 8
  v_add_u32 v40, 512, v40
  v_mfma_f32_32x32x16_bf16 v[72:87], v[168:171], v[32:35], 0
  v_mfma_f32_32x32x16_bf16 v[72:87], v[172:175], v[36:39], v[72:87]
  v_mfma_f32_32x32x16_bf16 v[88:103], v[176:179], v[32:35], 0
  v_mfma_f32_32x32x16_bf16 v[88:103], v[180:183], v[36:39], v[88:103]
  s_nop 9
  v_add_f32_dpp v72, v73, v72 row_ror:8 row_mask:0x5 bank_mask:0xf
  v_add_f32_dpp v72, v75, v74 row_ror:8 row_mask:0xa bank_mask:0xf
  v_add_f32_dpp v76, v77, v76 row_ror:8 row_mask:0x5 bank_mask:0xf
  v_add_f32_dpp v76, v79, v78 row_ror:8 row_mask:0xa bank_mask:0xf
  v_add_f32_dpp v80, v81, v80 row_ror:8 row_mask:0x5 bank_mask:0xf
  v_add_f32_dpp v80, v83, v82 row_ror:8 row_mask:0xa bank_mask:0xf
  v_add_f32_dpp v84, v85, v84 row_ror:8 row_mask:0x5 bank_mask:0xf
  v_add_f32_dpp v84, v87, v86 row_ror:8 row_mask:0xa bank_mask:0xf
  s_nop 1
  v_permlane16_swap_b32 v72, v76
  v_permlane16_swap_b32 v80, v84
  v_add_f32 v16, v72, v76
  v_add_f32 v17, v80, v84
  v_mfma_f32_32x32x16_bf16 v[72:87], v[184:187], v[32:35], 0
  v_mfma_f32_32x32x16_bf16 v[72:87], v[188:191], v[36:39], v[72:87]
  v_add_f32_dpp v88, v89, v88 row_ror:8 row_mask:0x5 bank_mask:0xf
  v_add_f32_dpp v88, v91, v90 row_ror:8 row_mask:0xa bank_mask:0xf
  v_add_f32_dpp v92, v93, v92 row_ror:8 row_mask:0x5 bank_mask:0xf
  v_add_f32_dpp v92, v95, v94 row_ror:8 row_mask:0xa bank_mask:0xf
  v_add_f32_dpp v96, v97, v96 row_ror:8 row_mask:0x5 bank_mask:0xf
  v_add_f32_dpp v96, v99, v98 row_ror:8 row_mask:0xa bank_mask:0xf
  v_add_f32_dpp v100, v101, v100 row_ror:8 row_mask:0x5 bank_mask:0xf
  v_add_f32_dpp v100, v103, v102 row_ror:8 row_mask:0xa bank_mask:0xf
  s_nop 1
  v_permlane16_swap_b32 v88, v92
  v_permlane16_swap_b32 v96, v100
  v_add_f32 v18, v88, v92
  v_add_f32 v19, v96, v100
  v_mfma_f32_32x32x16_bf16 v[88:103], v[192:195], v[32:35], 0
  v_mfma_f32_32x32x16_bf16 v[88:103], v[196:199], v[36:39], v[88:103]
  v_add_f32_dpp v72, v73, v72 row_ror:8 row_mask:0x5 bank_mask:0xf
  v_add_f32_dpp v72, v75, v74 row_ror:8 row_mask:0xa bank_mask:0xf
  v_add_f32_dpp v76, v77, v76 row_ror:8 row_mask:0x5 bank_mask:0xf
  v_add_f32_dpp v76, v79, v78 row_ror:8 row_mask:0xa bank_mask:0xf
  v_add_f32_dpp v80, v81, v80 row_ror:8 row_mask:0x5 bank_mask:0xf
  v_add_f32_dpp v80, v83, v82 row_ror:8 row_mask:0xa bank_mask:0xf
  v_add_f32_dpp v84, v85, v84 row_ror:8 row_mask:0x5 bank_mask:0xf
  v_add_f32_dpp v84, v87, v86 row_ror:8 row_mask:0xa bank_mask:0xf
  s_nop 1
  v_permlane16_swap_b32 v72, v76
  v_permlane16_swap_b32 v80, v84
  v_add_f32 v20, v72, v76
  v_add_f32 v21, v80, v84
  v_add_f32_dpp v88, v89, v88 row_ror:8 row_mask:0x5 bank_mask:0xf
  v_add_f32_dpp v88, v91, v90 row_ror:8 row_mask:0xa bank_mask:0xf
  v_add_f32_dpp v92, v93, v92 row_ror:8 row_mask:0x5 bank_mask:0xf
  v_add_f32_dpp v92, v95, v94 row_ror:8 row_mask:0xa bank_mask:0xf
  v_add_f32_dpp v96, v97, v96 row_ror:8 row_mask:0x5 bank_mask:0xf
  v_add_f32_dpp v96, v99, v98 row_ror:8 row_mask:0xa bank_mask:0xf
  v_add_f32_dpp v100, v101, v100 row_ror:8 row_mask:0x5 bank_mask:0xf
  v_add_f32_dpp v100, v103, v102 row_ror:8 row_mask:0xa bank_mask:0xf
  s_nop 1
  v_permlane16_swap_b32 v88, v92
  v_permlane16_swap_b32 v96, v100
  v_add_f32 v22, v88, v92
  v_add_f32 v23, v96, v100
  s_waitcnt vmcnt(7)
  ds_read_b128 v[168:171], v252 offset:0
  ds_read_b128 v[172:175], v252 offset:1024
  ds_read_b128 v[176:179], v252 offset:2048
  ds_read_b128 v[180:183], v252 offset:3072
  ds_read_b128 v[184:187], v252 offset:4096
  ds_read_b128 v[188:191], v252 offset:5120
  ds_read_b128 v[192:195], v252 offset:6144
  ds_read_b128 v[196:199], v252 offset:7168
  ds_read_b128 v[136:139], v252 offset:8192
  ds_read_b128 v[140:143], v252 offset:9216
  ds_read_b128 v[144:147], v252 offset:10240
  buffer_load_dwordx4 v[112:115], v1, s[20:23], s5 offen offset:0 nt
  buffer_load_dwordx4 v[116:119], v1, s[20:23], s5 offen offset:128 nt
  v_max3_f32 v8, v16, v17, v18
  v_max3_f32 v9, v19, v20, v21
  v_max3_f32 v8, v8, v22, v23
  v_max_f32 v8, v8, v9
  v_mov_b32 v9, v8
  s_nop 1
  v_permlane16_swap_b32 v9, v8
  v_max_f32 v8, v8, v9
  v_mov_b32 v9, v8
  s_nop 1
  v_permlane32_swap_b32 v9, v8
  v_max_f32 v8, v8, v9
  v_mul_f32 v8, s60, v8
  v_max_f32 v10, v5, v8
  v_sub_f32 v9, v5, v10
  v_exp_f32 v7, v9
  v_mov_b32 v5, v10
  v_fma_f32 v16, v16, s60, -v10
  v_fma_f32 v17, v17, s60, -v10
  v_fma_f32 v18, v18, s60, -v10
  v_fma_f32 v19, v19, s60, -v10
  v_fma_f32 v20, v20, s60, -v10
  v_fma_f32 v21, v21, s60, -v10
  v_fma_f32 v22, v22, s60, -v10
  v_fma_f32 v23, v23, s60, -v10
  v_exp_f32 v16, v16
  v_exp_f32 v17, v17
  v_exp_f32 v18, v18
  v_exp_f32 v19, v19
  v_exp_f32 v20, v20
  v_exp_f32 v21, v21
  v_exp_f32 v22, v22
  v_exp_f32 v23, v23
  v_mul_f32 v6, v6, v7
  v_cvt_pk_bf16_f32 v12, v16, v17
  v_cvt_pk_bf16_f32 v13, v18, v19
  v_cvt_pk_bf16_f32 v14, v20, v21
  v_cvt_pk_bf16_f32 v15, v22, v23
  v_add_f32 v8, v16, v17
  v_add_f32 v9, v18, v19
  v_add_f32 v20, v20, v21
  v_add_f32 v22, v22, v23
  v_add_f32 v8, v8, v9
  v_add_f32 v20, v20, v22
  v_add_f32 v6, v6, v8
  v_add_f32 v6, v6, v20
  v_mov_b32_dpp v7, v7 row_ror:8 row_mask:0xf bank_mask:0xc
  s_mov_b64 exec, s[70:71]
  ds_write_b128 v40, v[12:15]
  s_mov_b64 exec, -1
  v_cndmask_b32 v253, v253, v7, s[0:1]
  s_lshl_b64 s[0:1], s[0:1], 8
  v_add_u32 v40, 512, v40
  v_mfma_f32_32x32x16_bf16 v[72:87], v[200:203], v[32:35], 0
  v_mfma_f32_32x32x16_bf16 v[72:87], v[204:207], v[36:39], v[72:87]
  v_mfma_f32_32x32x16_bf16 v[88:103], v[208:211], v[32:35], 0
  v_mfma_f32_32x32x16_bf16 v[88:103], v[212:215], v[36:39], v[88:103]
  s_nop 9
  v_add_f32_dpp v72, v73, v72 row_ror:8 row_mask:0x5 bank_mask:0xf
  v_add_f32_dpp v72, v75, v74 row_ror:8 row_mask:0xa bank_mask:0xf
  v_add_f32_dpp v76, v77, v76 row_ror:8 row_mask:0x5 bank_mask:0xf
  v_add_f32_dpp v76, v79, v78 row_ror:8 row_mask:0xa bank_mask:0xf
  v_add_f32_dpp v80, v81, v80 row_ror:8 row_mask:0x5 bank_mask:0xf
  v_add_f32_dpp v80, v83, v82 row_ror:8 row_mask:0xa bank_mask:0xf
  v_add_f32_dpp v84, v85, v84 row_ror:8 row_mask:0x5 bank_mask:0xf
  v_add_f32_dpp v84, v87, v86 row_ror:8 row_mask:0xa bank_mask:0xf
  s_nop 1
  v_permlane16_swap_b32 v72, v76
  v_permlane16_swap_b32 v80, v84
  v_add_f32 v16, v72, v76
  v_add_f32 v17, v80, v84
  v_mfma_f32_32x32x16_bf16 v[72:87], v[216:219], v[32:35], 0
  v_mfma_f32_32x32x16_bf16 v[72:87], v[220:223], v[36:39], v[72:87]
  v_add_f32_dpp v88, v89, v88 row_ror:8 row_mask:0x5 bank_mask:0xf
  v_add_f32_dpp v88, v91, v90 row_ror:8 row_mask:0xa bank_mask:0xf
  v_add_f32_dpp v92, v93, v92 row_ror:8 row_mask:0x5 bank_mask:0xf
  v_add_f32_dpp v92, v95, v94 row_ror:8 row_mask:0xa bank_mask:0xf
  v_add_f32_dpp v96, v97, v96 row_ror:8 row_mask:0x5 bank_mask:0xf
  v_add_f32_dpp v96, v99, v98 row_ror:8 row_mask:0xa bank_mask:0xf
  v_add_f32_dpp v100, v101, v100 row_ror:8 row_mask:0x5 bank_mask:0xf
  v_add_f32_dpp v100, v103, v102 row_ror:8 row_mask:0xa bank_mask:0xf
  s_nop 1
  v_permlane16_swap_b32 v88, v92
  v_permlane16_swap_b32 v96, v100
  v_add_f32 v18, v88, v92
  v_add_f32 v19, v96, v100
  v_mfma_f32_32x32x16_bf16 v[88:103], v[224:227], v[32:35], 0
  v_mfma_f32_32x32x16_bf16 v[88:103], v[228:231], v[36:39], v[88:103]
  v_add_f32_dpp v72, v73, v72 row_ror:8 row_mask:0x5 bank_mask:0xf
  v_add_f32_dpp v72, v75, v74 row_ror:8 row_mask:0xa bank_mask:0xf
  v_add_f32_dpp v76, v77, v76 row_ror:8 row_mask:0x5 bank_mask:0xf
  v_add_f32_dpp v76, v79, v78 row_ror:8 row_mask:0xa bank_mask:0xf
  v_add_f32_dpp v80, v81, v80 row_ror:8 row_mask:0x5 bank_mask:0xf
  v_add_f32_dpp v80, v83, v82 row_ror:8 row_mask:0xa bank_mask:0xf
  v_add_f32_dpp v84, v85, v84 row_ror:8 row_mask:0x5 bank_mask:0xf
  v_add_f32_dpp v84, v87, v86 row_ror:8 row_mask:0xa bank_mask:0xf
  s_nop 1
  v_permlane16_swap_b32 v72, v76
  v_permlane16_swap_b32 v80, v84
  v_add_f32 v20, v72, v76
  v_add_f32 v21, v80, v84
  v_add_f32_dpp v88, v89, v88 row_ror:8 row_mask:0x5 bank_mask:0xf
  v_add_f32_dpp v88, v91, v90 row_ror:8 row_mask:0xa bank_mask:0xf
  v_add_f32_dpp v92, v93, v92 row_ror:8 row_mask:0x5 bank_mask:0xf
  v_add_f32_dpp v92, v95, v94 row_ror:8 row_mask:0xa bank_mask:0xf
  v_add_f32_dpp v96, v97, v96 row_ror:8 row_mask:0x5 bank_mask:0xf
  v_add_f32_dpp v96, v99, v98 row_ror:8 row_mask:0xa bank_mask:0xf
  v_add_f32_dpp v100, v101, v100 row_ror:8 row_mask:0x5 bank_mask:0xf
  v_add_f32_dpp v100, v103, v102 row_ror:8 row_mask:0xa bank_mask:0xf
  s_nop 1
  v_permlane16_swap_b32 v88, v92
  v_permlane16_swap_b32 v96, v100
  v_add_f32 v22, v88, v92
  v_add_f32 v23, v96, v100
  buffer_load_dwordx4 v[120:123], v1, s[20:23], s6 offen offset:0 nt
  buffer_load_dwordx4 v[124:127], v1, s[20:23], s6 offen offset:128 nt
  v_max3_f32 v8, v16, v17, v18
  v_max3_f32 v9, v19, v20, v21
  v_max3_f32 v8, v8, v22, v23
  v_max_f32 v8, v8, v9
  v_mov_b32 v9, v8
  s_nop 1
  v_permlane16_swap_b32 v9, v8
  v_max_f32 v8, v8, v9
  v_mov_b32 v9, v8
  s_nop 1
  v_permlane32_swap_b32 v9, v8
  v_max_f32 v8, v8, v9
  v_mul_f32 v8, s60, v8
  v_max_f32 v10, v5, v8
  v_sub_f32 v9, v5, v10
  v_exp_f32 v7, v9
  v_mov_b32 v5, v10
  v_fma_f32 v16, v16, s60, -v10
  v_fma_f32 v17, v17, s60, -v10
  v_fma_f32 v18, v18, s60, -v10
  v_fma_f32 v19, v19, s60, -v10
  v_fma_f32 v20, v20, s60, -v10
  v_fma_f32 v21, v21, s60, -v10
  v_fma_f32 v22, v22, s60, -v10
  v_fma_f32 v23, v23, s60, -v10
  v_exp_f32 v16, v16
  v_exp_f32 v17, v17
  v_exp_f32 v18, v18
  v_exp_f32 v19, v19
  v_exp_f32 v20, v20
  v_exp_f32 v21, v21
  v_exp_f32 v22, v22
  v_exp_f32 v23, v23
  v_mul_f32 v6, v6, v7
  v_cvt_pk_bf16_f32 v12, v16, v17
  v_cvt_pk_bf16_f32 v13, v18, v19
  v_cvt_pk_bf16_f32 v14, v20, v21
  v_cvt_pk_bf16_f32 v15, v22, v23
  v_add_f32 v8, v16, v17
  v_add_f32 v9, v18, v19
  v_add_f32 v20, v20, v21
  v_add_f32 v22, v22, v23
  v_add_f32 v8, v8, v9
  v_add_f32 v20, v20, v22
  v_add_f32 v6, v6, v8
  v_add_f32 v6, v6, v20
  v_mov_b32_dpp v7, v7 row_ror:8 row_mask:0xf bank_mask:0xc
  s_mov_b64 exec, s[70:71]
  ds_write_b128 v40, v[12:15]
  s_mov_b64 exec, -1
  v_cndmask_b32 v253, v253, v7, s[0:1]
  s_lshl_b64 s[0:1], s[0:1], 8
  v_add_u32 v40, 512, v40
  s_waitcnt lgkmcnt(0)
  v_mfma_f32_32x32x16_bf16 v[72:87], v[168:171], v[32:35], 0
  v_mfma_f32_32x32x16_bf16 v[72:87], v[172:175], v[36:39], v[72:87]
  v_mfma_f32_32x32x16_bf16 v[88:103], v[176:179], v[32:35], 0
  v_mfma_f32_32x32x16_bf16 v[88:103], v[180:183], v[36:39], v[88:103]
  s_nop 9
  v_add_f32_dpp v72, v73, v72 row_ror:8 row_mask:0x5 bank_mask:0xf
  v_add_f32_dpp v72, v75, v74 row_ror:8 row_mask:0xa bank_mask:0xf
  v_add_f32_dpp v76, v77, v76 row_ror:8 row_mask:0x5 bank_mask:0xf
  v_add_f32_dpp v76, v79, v78 row_ror:8 row_mask:0xa bank_mask:0xf
  v_add_f32_dpp v80, v81, v80 row_ror:8 row_mask:0x5 bank_mask:0xf
  v_add_f32_dpp v80, v83, v82 row_ror:8 row_mask:0xa bank_mask:0xf
  v_add_f32_dpp v84, v85, v84 row_ror:8 row_mask:0x5 bank_mask:0xf
  v_add_f32_dpp v84, v87, v86 row_ror:8 row_mask:0xa bank_mask:0xf
  s_nop 1
  v_permlane16_swap_b32 v72, v76
  v_permlane16_swap_b32 v80, v84
  v_add_f32 v16, v72, v76
  v_add_f32 v17, v80, v84
  v_mfma_f32_32x32x16_bf16 v[72:87], v[184:187], v[32:35], 0
  v_mfma_f32_32x32x16_bf16 v[72:87], v[188:191], v[36:39], v[72:87]
  v_add_f32_dpp v88, v89, v88 row_ror:8 row_mask:0x5 bank_mask:0xf
  v_add_f32_dpp v88, v91, v90 row_ror:8 row_mask:0xa bank_mask:0xf
  v_add_f32_dpp v92, v93, v92 row_ror:8 row_mask:0x5 bank_mask:0xf
  v_add_f32_dpp v92, v95, v94 row_ror:8 row_mask:0xa bank_mask:0xf
  v_add_f32_dpp v96, v97, v96 row_ror:8 row_mask:0x5 bank_mask:0xf
  v_add_f32_dpp v96, v99, v98 row_ror:8 row_mask:0xa bank_mask:0xf
  v_add_f32_dpp v100, v101, v100 row_ror:8 row_mask:0x5 bank_mask:0xf
  v_add_f32_dpp v100, v103, v102 row_ror:8 row_mask:0xa bank_mask:0xf
  s_nop 1
  v_permlane16_swap_b32 v88, v92
  v_permlane16_swap_b32 v96, v100
  v_add_f32 v18, v88, v92
  v_add_f32 v19, v96, v100
  v_mfma_f32_32x32x16_bf16 v[88:103], v[192:195], v[32:35], 0
  v_mfma_f32_32x32x16_bf16 v[88:103], v[196:199], v[36:39], v[88:103]
  v_add_f32_dpp v72, v73, v72 row_ror:8 row_mask:0x5 bank_mask:0xf
  v_add_f32_dpp v72, v75, v74 row_ror:8 row_mask:0xa bank_mask:0xf
  v_add_f32_dpp v76, v77, v76 row_ror:8 row_mask:0x5 bank_mask:0xf
  v_add_f32_dpp v76, v79, v78 row_ror:8 row_mask:0xa bank_mask:0xf
  v_add_f32_dpp v80, v81, v80 row_ror:8 row_mask:0x5 bank_mask:0xf
  v_add_f32_dpp v80, v83, v82 row_ror:8 row_mask:0xa bank_mask:0xf
  v_add_f32_dpp v84, v85, v84 row_ror:8 row_mask:0x5 bank_mask:0xf
  v_add_f32_dpp v84, v87, v86 row_ror:8 row_mask:0xa bank_mask:0xf
  s_nop 1
  v_permlane16_swap_b32 v72, v76
  v_permlane16_swap_b32 v80, v84
  v_add_f32 v20, v72, v76
  v_add_f32 v21, v80, v84
  v_add_f32_dpp v88, v89, v88 row_ror:8 row_mask:0x5 bank_mask:0xf
  v_add_f32_dpp v88, v91, v90 row_ror:8 row_mask:0xa bank_mask:0xf
  v_add_f32_dpp v92, v93, v92 row_ror:8 row_mask:0x5 bank_mask:0xf
  v_add_f32_dpp v92, v95, v94 row_ror:8 row_mask:0xa bank_mask:0xf
  v_add_f32_dpp v96, v97, v96 row_ror:8 row_mask:0x5 bank_mask:0xf
  v_add_f32_dpp v96, v99, v98 row_ror:8 row_mask:0xa bank_mask:0xf
  v_add_f32_dpp v100, v101, v100 row_ror:8 row_mask:0x5 bank_mask:0xf
  v_add_f32_dpp v100, v103, v102 row_ror:8 row_mask:0xa bank_mask:0xf
  s_nop 1
  v_permlane16_swap_b32 v88, v92
  v_permlane16_swap_b32 v96, v100
  v_add_f32 v22, v88, v92
  v_add_f32 v23, v96, v100
  buffer_load_dwordx4 v[128:131], v1, s[20:23], s7 offen offset:0 nt
  buffer_load_dwordx4 v[132:135], v1, s[20:23], s7 offen offset:128 nt
  v_max3_f32 v8, v16, v17, v18
  v_max3_f32 v9, v19, v20, v21
  v_max3_f32 v8, v8, v22, v23
  v_max_f32 v8, v8, v9
  v_mov_b32 v9, v8
  s_nop 1
  v_permlane16_swap_b32 v9, v8
  v_max_f32 v8, v8, v9
  v_mov_b32 v9, v8
  s_nop 1
  v_permlane32_swap_b32 v9, v8
  v_max_f32 v8, v8, v9
  v_mul_f32 v8, s60, v8
  v_max_f32 v10, v5, v8
  v_sub_f32 v9, v5, v10
  v_exp_f32 v7, v9
  v_mov_b32 v5, v10
  v_fma_f32 v16, v16, s60, -v10
  v_fma_f32 v17, v17, s60, -v10
  v_fma_f32 v18, v18, s60, -v10
  v_fma_f32 v19, v19, s60, -v10
  v_fma_f32 v20, v20, s60, -v10
  v_fma_f32 v21, v21, s60, -v10
  v_fma_f32 v22, v22, s60, -v10
  v_fma_f32 v23, v23, s60, -v10
  v_exp_f32 v16, v16
  v_exp_f32 v17, v17
  v_exp_f32 v18, v18
  v_exp_f32 v19, v19
  v_exp_f32 v20, v20
  v_exp_f32 v21, v21
  v_exp_f32 v22, v22
  v_exp_f32 v23, v23
  v_mul_f32 v6, v6, v7
  v_cvt_pk_bf16_f32 v12, v16, v17
  v_cvt_pk_bf16_f32 v13, v18, v19
  v_cvt_pk_bf16_f32 v14, v20, v21
  v_cvt_pk_bf16_f32 v15, v22, v23
  v_add_f32 v8, v16, v17
  v_add_f32 v9, v18, v19
  v_add_f32 v20, v20, v21
  v_add_f32 v22, v22, v23
  v_add_f32 v8, v8, v9
  v_add_f32 v20, v20, v22
  v_add_f32 v6, v6, v8
  v_add_f32 v6, v6, v20
  v_mov_b32_dpp v7, v7 row_ror:8 row_mask:0xf bank_mask:0xc
  s_mov_b64 exec, s[70:71]
  ds_write_b128 v40, v[12:15]
  s_mov_b64 exec, -1
  v_cndmask_b32 v253, v253, v7, s[0:1]
  s_lshl_b64 s[0:1], s[0:1], 8
  v_add_u32 v40, 512, v40
  s_waitcnt vmcnt(8)
  v_mfma_f32_32x32x16_bf16 v[72:87], v[136:139], v[32:35], 0
  v_mfma_f32_32x32x16_bf16 v[72:87], v[140:143], v[36:39], v[72:87]
  v_mfma_f32_32x32x16_bf16 v[88:103], v[144:147], v[32:35], 0
  v_mfma_f32_32x32x16_bf16 v[88:103], v[148:151], v[36:39], v[88:103]
  s_nop 9
  v_add_f32_dpp v72, v73, v72 row_ror:8 row_mask:0x5 bank_mask:0xf
  v_add_f32_dpp v72, v75, v74 row_ror:8 row_mask:0xa bank_mask:0xf
  v_add_f32_dpp v76, v77, v76 row_ror:8 row_mask:0x5 bank_mask:0xf
  v_add_f32_dpp v76, v79, v78 row_ror:8 row_mask:0xa bank_mask:0xf
  v_add_f32_dpp v80, v81, v80 row_ror:8 row_mask:0x5 bank_mask:0xf
  v_add_f32_dpp v80, v83, v82 row_ror:8 row_mask:0xa bank_mask:0xf
  v_add_f32_dpp v84, v85, v84 row_ror:8 row_mask:0x5 bank_mask:0xf
  v_add_f32_dpp v84, v87, v86 row_ror:8 row_mask:0xa bank_mask:0xf
  s_nop 1
  v_permlane16_swap_b32 v72, v76
  v_permlane16_swap_b32 v80, v84
  v_add_f32 v16, v72, v76
  v_add_f32 v17, v80, v84
  v_mfma_f32_32x32x16_bf16 v[72:87], v[152:155], v[32:35], 0
  v_mfma_f32_32x32x16_bf16 v[72:87], v[156:159], v[36:39], v[72:87]
  v_add_f32_dpp v88, v89, v88 row_ror:8 row_mask:0x5 bank_mask:0xf
  v_add_f32_dpp v88, v91, v90 row_ror:8 row_mask:0xa bank_mask:0xf
  v_add_f32_dpp v92, v93, v92 row_ror:8 row_mask:0x5 bank_mask:0xf
  v_add_f32_dpp v92, v95, v94 row_ror:8 row_mask:0xa bank_mask:0xf
  v_add_f32_dpp v96, v97, v96 row_ror:8 row_mask:0x5 bank_mask:0xf
  v_add_f32_dpp v96, v99, v98 row_ror:8 row_mask:0xa bank_mask:0xf
  v_add_f32_dpp v100, v101, v100 row_ror:8 row_mask:0x5 bank_mask:0xf
  v_add_f32_dpp v100, v103, v102 row_ror:8 row_mask:0xa bank_mask:0xf
  s_nop 1
  v_permlane16_swap_b32 v88, v92
  v_permlane16_swap_b32 v96, v100
  v_add_f32 v18, v88, v92
  v_add_f32 v19, v96, v100
  v_mfma_f32_32x32x16_bf16 v[88:103], v[160:163], v[32:35], 0
  v_mfma_f32_32x32x16_bf16 v[88:103], v[164:167], v[36:39], v[88:103]
  v_add_f32_dpp v72, v73, v72 row_ror:8 row_mask:0x5 bank_mask:0xf
  v_add_f32_dpp v72, v75, v74 row_ror:8 row_mask:0xa bank_mask:0xf
  v_add_f32_dpp v76, v77, v76 row_ror:8 row_mask:0x5 bank_mask:0xf
  v_add_f32_dpp v76, v79, v78 row_ror:8 row_mask:0xa bank_mask:0xf
  v_add_f32_dpp v80, v81, v80 row_ror:8 row_mask:0x5 bank_mask:0xf
  v_add_f32_dpp v80, v83, v82 row_ror:8 row_mask:0xa bank_mask:0xf
  v_add_f32_dpp v84, v85, v84 row_ror:8 row_mask:0x5 bank_mask:0xf
  v_add_f32_dpp v84, v87, v86 row_ror:8 row_mask:0xa bank_mask:0xf
  s_nop 1
  v_permlane16_swap_b32 v72, v76
  v_permlane16_swap_b32 v80, v84
  v_add_f32 v20, v72, v76
  v_add_f32 v21, v80, v84
  v_add_f32_dpp v88, v89, v88 row_ror:8 row_mask:0x5 bank_mask:0xf
  v_add_f32_dpp v88, v91, v90 row_ror:8 row_mask:0xa bank_mask:0xf
  v_add_f32_dpp v92, v93, v92 row_ror:8 row_mask:0x5 bank_mask:0xf
  v_add_f32_dpp v92, v95, v94 row_ror:8 row_mask:0xa bank_mask:0xf
  v_add_f32_dpp v96, v97, v96 row_ror:8 row_mask:0x5 bank_mask:0xf
  v_add_f32_dpp v96, v99, v98 row_ror:8 row_mask:0xa bank_mask:0xf
  v_add_f32_dpp v100, v101, v100 row_ror:8 row_mask:0x5 bank_mask:0xf
  v_add_f32_dpp v100, v103, v102 row_ror:8 row_mask:0xa bank_mask:0xf
  s_nop 1
  v_permlane16_swap_b32 v88, v92
  v_permlane16_swap_b32 v96, v100
  v_add_f32 v22, v88, v92
  v_add_f32 v23, v96, v100
  v_max3_f32 v8, v16, v17, v18
  v_max3_f32 v9, v19, v20, v21
  v_max3_f32 v8, v8, v22, v23
  v_max_f32 v8, v8, v9
  v_mov_b32 v9, v8
  s_nop 1
  v_permlane16_swap_b32 v9, v8
  v_max_f32 v8, v8, v9
  v_mov_b32 v9, v8
  s_nop 1
  v_permlane32_swap_b32 v9, v8
  v_max_f32 v8, v8, v9
  v_mul_f32 v8, s60, v8
  v_max_f32 v10, v5, v8
  v_sub_f32 v9, v5, v10
  v_exp_f32 v7, v9
  v_mov_b32 v5, v10
  v_fma_f32 v16, v16, s60, -v10
  v_fma_f32 v17, v17, s60, -v10
  v_fma_f32 v18, v18, s60, -v10
  v_fma_f32 v19, v19, s60, -v10
  v_fma_f32 v20, v20, s60, -v10
  v_fma_f32 v21, v21, s60, -v10
  v_fma_f32 v22, v22, s60, -v10
  v_fma_f32 v23, v23, s60, -v10
  v_exp_f32 v16, v16
  v_exp_f32 v17, v17
  v_exp_f32 v18, v18
  v_exp_f32 v19, v19
  v_exp_f32 v20, v20
  v_exp_f32 v21, v21
  v_exp_f32 v22, v22
  v_exp_f32 v23, v23
  v_mul_f32 v6, v6, v7
  v_cvt_pk_bf16_f32 v12, v16, v17
  v_cvt_pk_bf16_f32 v13, v18, v19
  v_cvt_pk_bf16_f32 v14, v20, v21
  v_cvt_pk_bf16_f32 v15, v22, v23
  v_add_f32 v8, v16, v17
  v_add_f32 v9, v18, v19
  v_add_f32 v20, v20, v21
  v_add_f32 v22, v22, v23
  v_add_f32 v8, v8, v9
  v_add_f32 v20, v20, v22
  v_add_f32 v6, v6, v8
  v_add_f32 v6, v6, v20
  v_mov_b32_dpp v7, v7 row_ror:8 row_mask:0xf bank_mask:0xc
  s_mov_b64 exec, s[70:71]
  ds_write_b128 v40, v[12:15]
  s_mov_b64 exec, -1
  v_cndmask_b32 v253, v253, v7, s[0:1]
  s_lshl_b64 s[0:1], s[0:1], 8
  v_add_u32 v40, 512, v40
  s_load_dword s14, s[16:17], 128
L_top:
  s_memrealtime s[8:9]
  s_cmp_lt_u32 s73, 3
  s_cbranch_scc1 L_nosmpk
  s_cmp_lt_u32 s14, 16
  s_cbranch_scc1 L_nosmpk
  s_cmp_ge_u32 s73, 14
  s_cbranch_scc1 L_nosmpk
  s_lshl_b32 s61, s73, 11
  s_add_u32 s61, s61, 3178496
  s_add_u32 s76, s18, s61
  s_addc_u32 s77, s19, 0
  s_load_dword s80, s[76:77], 0
  s_load_dword s81, s[76:77], 128
  s_load_dword s82, s[76:77], 256
  s_load_dword s83, s[76:77], 384
  s_load_dword s84, s[76:77], 512
  s_load_dword s85, s[76:77], 640
  s_load_dword s86, s[76:77], 768
  s_load_dword s87, s[76:77], 896
  s_load_dword s88, s[76:77], 1024
  s_load_dword s89, s[76:77], 1152
  s_load_dword s90, s[76:77], 1280
  s_load_dword s91, s[76:77], 1408
  s_load_dword s92, s[76:77], 1536
  s_load_dword s93, s[76:77], 1664
  s_load_dword s94, s[76:77], 1792
  s_load_dword s95, s[76:77], 1920
L_nosmpk:
  s_add_u32 s73, s73, 1
  s_add_u32 s56, s56, 1
  s_and_b32 s57, s56, 8
  s_lshl_b32 s57, s57, 21
  s_add_u32 s57, s57, s74
  s_add_u32 s75, s75, 1
  s_bfe_u32 s64, s75, 0x10000
  s_lshl_b32 s64, s64, 10
  s_add_u32 s57, s57, s64
  s_bfe_u32 s64, s75, 0x10001
  s_lshl_b32 s64, s64, 18
  s_add_u32 s57, s57, s64
  s_bfe_u32 s64, s75, 0x10002
  s_lshl_b32 s64, s64, 14
  s_add_u32 s57, s57, s64
  s_add_u32 s4, s57, s96
  s_add_u32 s5, s57, s97
  s_add_u32 s6, s57, s98
  s_add_u32 s7, s57, s99
  s_bitcmp1_b32 0x18, s73
  s_cselect_b32 s31, 1, 0
  s_lshl_b32 s32, s30, 17
  s_add_u32 s32, s32, s78
  s_add_u32 s30, s30, s31
  s_bitcmp1_b32 s11, 12
  s_cbranch_scc1 L_t3
  s_bitcmp0_b32 s10, 12
  s_cbranch_scc1 L_t2
  s_waitcnt vmcnt(1)
L_t2:
  s_waitcnt vmcnt(2)
L_t3:
  s_waitcnt vmcnt(4)
  buffer_load_dwordx4 v[136:139], v1, s[20:23], s4 offen offset:0 nt
  s_cmp_eq_u32 s31, 0
  s_cbranch_scc1 L_t4
  s_add_u32 m0, s68, 0
  s_add_u32 s64, s32, 0x0
  buffer_load_dwordx4 v0, s[36:39], s64 offen nt lds
L_t4:
  s_bitcmp1_b32 s11, 13
  s_cbranch_scc1 L_t6
  s_bitcmp0_b32 s10, 13
  s_cbranch_scc1 L_t5
  s_waitcnt vmcnt(1)
L_t5:
  s_waitcnt vmcnt(2)
L_t6:
  s_waitcnt vmcnt(4)
  buffer_load_dwordx4 v[140:143], v1, s[20:23], s4 offen offset:128 nt
  s_bitcmp1_b32 s11, 14
  s_cbranch_scc1 L_t8
  s_bitcmp0_b32 s10, 14
  s_cbranch_scc1 L_t7
  s_waitcnt vmcnt(1)
L_t7:
  s_waitcnt vmcnt(2)
L_t8:
  s_waitcnt vmcnt(4)
  buffer_load_dwordx4 v[144:147], v1, s[20:23], s5 offen offset:0 nt
  s_cmp_eq_u32 s31, 0
  s_cbranch_scc1 L_t9
  s_add_u32 m0, s68, 1024
  s_add_u32 s64, s32, 0x4000
  buffer_load_dwordx4 v0, s[36:39], s64 offen nt lds
L_t9:
  s_bitcmp1_b32 s11, 15
  s_cbranch_scc1 L_t11
  s_bitcmp0_b32 s10, 15
  s_cbranch_scc1 L_t10
  s_waitcnt vmcnt(1)
L_t10:
  s_waitcnt vmcnt(2)
L_t11:
  s_waitcnt vmcnt(4)
  buffer_load_dwordx4 v[148:151], v1, s[20:23], s5 offen offset:128 nt
  s_waitcnt lgkmcnt(0)
  s_min_u32 s8, s8, -2
  s_and_b32 s61, s73, 7
  s_cmp_lg_u32 s15, s61
  s_cbranch_scc1 L_nopubk
  s_cmp_ge_u32 s73, 14
  s_cbranch_scc1 L_nopubk
  s_lshl_b32 s61, s73, 11
  s_add_u32 s61, s61, s35
  v_mov_b32 v8, s8
  s_mov_b64 exec, 1
  buffer_store_dword v8, off, s[40:43], s61 sc1
  s_mov_b64 exec, -1
L_nopubk:
  s_cmp_lt_u32 s73, 4
  s_cbranch_scc1 L_nolvlk
  s_cmp_lt_u32 s14, 16
  s_cbranch_scc1 L_nolvlk
  s_cmp_gt_u32 s73, 14
  s_cbranch_scc1 L_nolvlk
  s_mov_b32 s61, 0
  s_sub_u32 s62, s8, s80
  s_cmp_lt_u32 s62, 2000
  s_cselect_b32 s62, s62, 0
  s_add_u32 s61, s61, s62
  s_sub_u32 s62, s8, s81
  s_cmp_lt_u32 s62, 2000
  s_cselect_b32 s62, s62, 0
  s_add_u32 s61, s61, s62
  s_sub_u32 s62, s8, s82
  s_cmp_lt_u32 s62, 2000
  s_cselect_b32 s62, s62, 0
  s_add_u32 s61, s61, s62
  s_sub_u32 s62, s8, s83
  s_cmp_lt_u32 s62, 2000
  s_cselect_b32 s62, s62, 0
  s_add_u32 s61, s61, s62
  s_sub_u32 s62, s8, s84
  s_cmp_lt_u32 s62, 2000
  s_cselect_b32 s62, s62, 0
  s_add_u32 s61, s61, s62
  s_sub_u32 s62, s8, s85
  s_cmp_lt_u32 s62, 2000
  s_cselect_b32 s62, s62, 0
  s_add_u32 s61, s61, s62
  s_sub_u32 s62, s8, s86
  s_cmp_lt_u32 s62, 2000
  s_cselect_b32 s62, s62, 0
  s_add_u32 s61, s61, s62
  s_sub_u32 s62, s8, s87
  s_cmp_lt_u32 s62, 2000
  s_cselect_b32 s62, s62, 0
  s_add_u32 s61, s61, s62
  s_sub_u32 s62, s8, s88
  s_cmp_lt_u32 s62, 2000
  s_cselect_b32 s62, s62, 0
  s_add_u32 s61, s61, s62
  s_sub_u32 s62, s8, s89
  s_cmp_lt_u32 s62, 2000
  s_cselect_b32 s62, s62, 0
  s_add_u32 s61, s61, s62
  s_sub_u32 s62, s8, s90
  s_cmp_lt_u32 s62, 2000
  s_cselect_b32 s62, s62, 0
  s_add_u32 s61, s61, s62
  s_sub_u32 s62, s8, s91
  s_cmp_lt_u32 s62, 2000
  s_cselect_b32 s62, s62, 0
  s_add_u32 s61, s61, s62
  s_sub_u32 s62, s8, s92
  s_cmp_lt_u32 s62, 2000
  s_cselect_b32 s62, s62, 0
  s_add_u32 s61, s61, s62
  s_sub_u32 s62, s8, s93
  s_cmp_lt_u32 s62, 2000
  s_cselect_b32 s62, s62, 0
  s_add_u32 s61, s61, s62
  s_sub_u32 s62, s8, s94
  s_cmp_lt_u32 s62, 2000
  s_cselect_b32 s62, s62, 0
  s_add_u32 s61, s61, s62
  s_sub_u32 s62, s8, s95
  s_cmp_lt_u32 s62, 2000
  s_cselect_b32 s62, s62, 0
  s_add_u32 s61, s61, s62
  s_lshr_b32 s61, s61, 4
  s_sub_u32 s61, s8, s61
  s_add_u32 s61, s61, s12
  s_sub_u32 s61, s13, s61
  s_mul_i32 s61, s61, 5
  s_ashr_i32 s61, s61, 7
  s_sub_i32 s61, 0, s61
  s_max_i32 s62, s61, 0
  s_min_i32 s62, s62, 16
  s_sub_i32 s61, 0, s61
  s_max_i32 s61, s61, 0
  s_mul_i32 s61, s61, 2
  s_min_i32 s61, s61, 16
  s_add_u32 s13, s8, s12
  s_bfm_b32 s11, s61, 0
  s_bfm_b32 s10, s62, 0
  s_mul_i32 s61, s61, 4
  s_add_u32 s12, s12, s61
  s_sub_i32 s62, 0, s62
  s_mul_i32 s62, s62, 12
  s_add_u32 s12, s12, s62
  s_branch L_lvdk
L_nolvlk:
  s_add_u32 s13, s8, s12
L_lvdk:
  s_bitcmp1_b32 s11, 0
  s_cbranch_scc1 L_t13
  s_bitcmp0_b32 s10, 0
  s_cbranch_scc1 L_t12
  s_waitcnt vmcnt(1)
L_t12:
  s_waitcnt vmcnt(2)
L_t13:
  s_waitcnt vmcnt(4)
  buffer_load_dwordx4 v[152:155], v1, s[20:23], s6 offen offset:0 nt
  s_cmp_eq_u32 s31, 0
  s_cbranch_scc1 L_t14
  s_add_u32 m0, s68, 4096
  s_add_u32 s64, s32, 0x10000
  buffer_load_dwordx4 v0, s[36:39], s64 offen nt lds
L_t14:
  v_mfma_f32_32x32x16_bf16 v[72:87], v[104:107], v[32:35], 0
  v_mfma_f32_32x32x16_bf16 v[72:87], v[108:111], v[36:39], v[72:87]
  v_mfma_f32_32x32x16_bf16 v[88:103], v[112:115], v[32:35], 0
  v_mfma_f32_32x32x16_bf16 v[88:103], v[116:119], v[36:39], v[88:103]
  s_nop 9
  v_add_f32_dpp v72, v73, v72 row_ror:8 row_mask:0x5 bank_mask:0xf
  v_add_f32_dpp v72, v75, v74 row_ror:8 row_mask:0xa bank_mask:0xf
  v_add_f32_dpp v76, v77, v76 row_ror:8 row_mask:0x5 bank_mask:0xf
  v_add_f32_dpp v76, v79, v78 row_ror:8 row_mask:0xa bank_mask:0xf
  v_add_f32_dpp v80, v81, v80 row_ror:8 row_mask:0x5 bank_mask:0xf
  v_add_f32_dpp v80, v83, v82 row_ror:8 row_mask:0xa bank_mask:0xf
  v_add_f32_dpp v84, v85, v84 row_ror:8 row_mask:0x5 bank_mask:0xf
  v_add_f32_dpp v84, v87, v86 row_ror:8 row_mask:0xa bank_mask:0xf
  s_nop 1
  v_permlane16_swap_b32 v72, v76
  v_permlane16_swap_b32 v80, v84
  v_add_f32 v16, v72, v76
  v_add_f32 v17, v80, v84
  v_mfma_f32_32x32x16_bf16 v[72:87], v[120:123], v[32:35], 0
  v_mfma_f32_32x32x16_bf16 v[72:87], v[124:127], v[36:39], v[72:87]
  v_add_f32_dpp v88, v89, v88 row_ror:8 row_mask:0x5 bank_mask:0xf
  v_add_f32_dpp v88, v91, v90 row_ror:8 row_mask:0xa bank_mask:0xf
  v_add_f32_dpp v92, v93, v92 row_ror:8 row_mask:0x5 bank_mask:0xf
  v_add_f32_dpp v92, v95, v94 row_ror:8 row_mask:0xa bank_mask:0xf
  v_add_f32_dpp v96, v97, v96 row_ror:8 row_mask:0x5 bank_mask:0xf
  v_add_f32_dpp v96, v99, v98 row_ror:8 row_mask:0xa bank_mask:0xf
  v_add_f32_dpp v100, v101, v100 row_ror:8 row_mask:0x5 bank_mask:0xf
  v_add_f32_dpp v100, v103, v102 row_ror:8 row_mask:0xa bank_mask:0xf
  s_nop 1
  v_permlane16_swap_b32 v88, v92
  v_permlane16_swap_b32 v96, v100
  v_add_f32 v18, v88, v92
  v_add_f32 v19, v96, v100
  v_mfma_f32_32x32x16_bf16 v[88:103], v[128:131], v[32:35], 0
  v_mfma_f32_32x32x16_bf16 v[88:103], v[132:135], v[36:39], v[88:103]
  v_add_f32_dpp v72, v73, v72 row_ror:8 row_mask:0x5 bank_mask:0xf
  v_add_f32_dpp v72, v75, v74 row_ror:8 row_mask:0xa bank_mask:0xf
  v_add_f32_dpp v76, v77, v76 row_ror:8 row_mask:0x5 bank_mask:0xf
  v_add_f32_dpp v76, v79, v78 row_ror:8 row_mask:0xa bank_mask:0xf
  v_add_f32_dpp v80, v81, v80 row_ror:8 row_mask:0x5 bank_mask:0xf
  v_add_f32_dpp v80, v83, v82 row_ror:8 row_mask:0xa bank_mask:0xf
  v_add_f32_dpp v84, v85, v84 row_ror:8 row_mask:0x5 bank_mask:0xf
  v_add_f32_dpp v84, v87, v86 row_ror:8 row_mask:0xa bank_mask:0xf
  s_nop 1
  v_permlane16_swap_b32 v72, v76
  v_permlane16_swap_b32 v80, v84
  v_add_f32 v20, v72, v76
  v_add_f32 v21, v80, v84
  v_add_f32_dpp v88, v89, v88 row_ror:8 row_mask:0x5 bank_mask:0xf
  v_add_f32_dpp v88, v91, v90 row_ror:8 row_mask:0xa bank_mask:0xf
  v_add_f32_dpp v92, v93, v92 row_ror:8 row_mask:0x5 bank_mask:0xf
  v_add_f32_dpp v92, v95, v94 row_ror:8 row_mask:0xa bank_mask:0xf
  v_add_f32_dpp v96, v97, v96 row_ror:8 row_mask:0x5 bank_mask:0xf
  v_add_f32_dpp v96, v99, v98 row_ror:8 row_mask:0xa bank_mask:0xf
  v_add_f32_dpp v100, v101, v100 row_ror:8 row_mask:0x5 bank_mask:0xf
  v_add_f32_dpp v100, v103, v102 row_ror:8 row_mask:0xa bank_mask:0xf
  s_nop 1
  v_permlane16_swap_b32 v88, v92
  v_permlane16_swap_b32 v96, v100
  v_add_f32 v22, v88, v92
  v_add_f32 v23, v96, v100
  s_bitcmp1_b32 s11, 1
  s_cbranch_scc1 L_t16
  s_bitcmp0_b32 s10, 1
  s_cbranch_scc1 L_t15
  s_waitcnt vmcnt(1)
L_t15:
  s_waitcnt vmcnt(2)
L_t16:
  s_waitcnt vmcnt(4)
  buffer_load_dwordx4 v[156:159], v1, s[20:23], s6 offen offset:128 nt
  v_max3_f32 v8, v16, v17, v18
  v_max3_f32 v9, v19, v20, v21
  v_max3_f32 v8, v8, v22, v23
  v_max_f32 v8, v8, v9
  v_mov_b32 v9, v8
  s_nop 1
  v_permlane16_swap_b32 v9, v8
  v_max_f32 v8, v8, v9
  v_mov_b32 v9, v8
  s_nop 1
  v_permlane32_swap_b32 v9, v8
  v_max_f32 v8, v8, v9
  v_mul_f32 v8, s60, v8
  v_max_f32 v10, v5, v8
  v_sub_f32 v9, v5, v10
  v_exp_f32 v7, v9
  v_mov_b32 v5, v10
  v_fma_f32 v16, v16, s60, -v10
  v_fma_f32 v17, v17, s60, -v10
  v_fma_f32 v18, v18, s60, -v10
  v_fma_f32 v19, v19, s60, -v10
  v_fma_f32 v20, v20, s60, -v10
  v_fma_f32 v21, v21, s60, -v10
  v_fma_f32 v22, v22, s60, -v10
  v_fma_f32 v23, v23, s60, -v10
  v_exp_f32 v16, v16
  v_exp_f32 v17, v17
  v_exp_f32 v18, v18
  v_exp_f32 v19, v19
  v_exp_f32 v20, v20
  v_exp_f32 v21, v21
  v_exp_f32 v22, v22
  v_exp_f32 v23, v23
  v_mul_f32 v6, v6, v7
  v_cvt_pk_bf16_f32 v12, v16, v17
  v_cvt_pk_bf16_f32 v13, v18, v19
  v_cvt_pk_bf16_f32 v14, v20, v21
  v_cvt_pk_bf16_f32 v15, v22, v23
  v_add_f32 v8, v16, v17
  v_add_f32 v9, v18, v19
  v_add_f32 v20, v20, v21
  v_add_f32 v22, v22, v23
  v_add_f32 v8, v8, v9
  v_add_f32 v20, v20, v22
  v_add_f32 v6, v6, v8
  v_add_f32 v6, v6, v20
  v_mov_b32_dpp v7, v7 row_ror:8 row_mask:0xf bank_mask:0xc
  s_mov_b64 exec, s[70:71]
  ds_write_b128 v40, v[12:15]
  s_mov_b64 exec, -1
  v_cndmask_b32 v253, v253, v7, s[0:1]
  s_lshl_b64 s[0:1], s[0:1], 8
  v_add_u32 v40, 512, v40
  s_bitcmp1_b32 s11, 2
  s_cbranch_scc1 L_t18
  s_bitcmp0_b32 s10, 2
  s_cbranch_scc1 L_t17
  s_waitcnt vmcnt(1)
L_t17:
  s_waitcnt vmcnt(2)
L_t18:
  s_waitcnt vmcnt(4)
  buffer_load_dwordx4 v[160:163], v1, s[20:23], s7 offen offset:0 nt
  s_cmp_eq_u32 s31, 0
  s_cbranch_scc1 L_t19
  s_add_u32 m0, s68, 5120
  s_add_u32 s64, s32, 0x14000
  buffer_load_dwordx4 v0, s[36:39], s64 offen nt lds
L_t19:
  s_bitcmp1_b32 s11, 3
  s_cbranch_scc1 L_t21
  s_bitcmp0_b32 s10, 3
  s_cbranch_scc1 L_t20
  s_waitcnt vmcnt(1)
L_t20:
  s_waitcnt vmcnt(2)
L_t21:
  s_waitcnt vmcnt(4)
  buffer_load_dwordx4 v[164:167], v1, s[20:23], s7 offen offset:128 nt
  s_cmp_eq_u32 s31, 0
  s_cbranch_scc1 L_t22
  s_add_u32 m0, s68, 2048
  s_add_u32 s64, s32, 0x8000
  buffer_load_dwordx4 v0, s[36:39], s64 offen nt lds
L_t22:
  s_add_u32 s56, s56, 1
  s_and_b32 s57, s56, 8
  s_lshl_b32 s57, s57, 21
  s_add_u32 s57, s57, s74
  s_add_u32 s75, s75, 1
  s_bfe_u32 s64, s75, 0x10000
  s_lshl_b32 s64, s64, 10
  s_add_u32 s57, s57, s64
  s_bfe_u32 s64, s75, 0x10001
  s_lshl_b32 s64, s64, 18
  s_add_u32 s57, s57, s64
  s_bfe_u32 s64, s75, 0x10002
  s_lshl_b32 s64, s64, 14
  s_add_u32 s57, s57, s64
  s_add_u32 s4, s57, s96
  s_add_u32 s5, s57, s97
  s_add_u32 s6, s57, s98
  s_add_u32 s7, s57, s99
  s_cmp_lg_u32 s73, 7
  s_cbranch_scc1 L_kb
  s_mov_b32 s20, s24
  s_mov_b32 s21, s25
  v_and_b32 v2, 0xff, v3
  v_bfe_u32 v4, v11, 4, 1
  v_lshl_add_u32 v2, v4, 13, v2
  v_bfe_u32 v4, v11, 5, 1
  v_lshl_add_u32 v2, v4, 9, v2
  v_add_u32 v4, 131072, v2
L_kb:
  s_bitcmp1_b32 s11, 4
  s_cbranch_scc1 L_t24
  s_bitcmp0_b32 s10, 4
  s_cbranch_scc1 L_t23
  s_waitcnt vmcnt(1)
L_t23:
  s_waitcnt vmcnt(2)
L_t24:
  s_waitcnt vmcnt(4)
  buffer_load_dwordx4 v[104:107], v2, s[20:23], s4 offen nt
  s_cmp_eq_u32 s31, 0
  s_cbranch_scc1 L_t25
  s_add_u32 m0, s68, 3072
  s_add_u32 s64, s32, 0xc000
  buffer_load_dwordx4 v0, s[36:39], s64 offen nt lds
L_t25:
  s_bitcmp1_b32 s11, 5
  s_cbranch_scc1 L_t27
  s_bitcmp0_b32 s10, 5
  s_cbranch_scc1 L_t26
  s_waitcnt vmcnt(1)
L_t26:
  s_waitcnt vmcnt(2)
L_t27:
  s_waitcnt vmcnt(4)
  buffer_load_dwordx4 v[108:111], v4, s[20:23], s4 offen nt
  s_cmp_eq_u32 s31, 0
  s_cbranch_scc1 L_t28
  s_add_u32 m0, s68, 6144
  s_add_u32 s64, s32, 0x18000
  buffer_load_dwordx4 v0, s[36:39], s64 offen nt lds
L_t28:
  s_bitcmp1_b32 s11, 6
  s_cbranch_scc1 L_t30
  s_bitcmp0_b32 s10, 6
  s_cbranch_scc1 L_t29
  s_waitcnt vmcnt(1)
L_t29:
  s_waitcnt vmcnt(2)
L_t30:
  s_waitcnt vmcnt(4)
  buffer_load_dwordx4 v[112:115], v2, s[20:23], s5 offen nt
  s_cmp_eq_u32 s31, 0
  s_cbranch_scc1 L_t31
  s_add_u32 m0, s68, 7168
  s_add_u32 s64, s32, 0x1c000
  buffer_load_dwordx4 v0, s[36:39], s64 offen nt lds
L_t31:
  s_bitcmp1_b32 s11, 7
  s_cbranch_scc1 L_t33
  s_bitcmp0_b32 s10, 7
  s_cbranch_scc1 L_t32
  s_waitcnt vmcnt(1)
L_t32:
  s_waitcnt vmcnt(2)
L_t33:
  s_waitcnt vmcnt(4)
  buffer_load_dwordx4 v[116:119], v4, s[20:23], s5 offen nt
  s_bitcmp1_b32 s11, 8
  s_cbranch_scc1 L_t35
  s_bitcmp0_b32 s10, 8
  s_cbranch_scc1 L_t34
  s_waitcnt vmcnt(1)
L_t34:
  s_waitcnt vmcnt(2)
L_t35:
  s_waitcnt vmcnt(4)
  buffer_load_dwordx4 v[120:123], v2, s[20:23], s6 offen nt
  v_mfma_f32_32x32x16_bf16 v[72:87], v[136:139], v[32:35], 0
  v_mfma_f32_32x32x16_bf16 v[72:87], v[140:143], v[36:39], v[72:87]
  v_mfma_f32_32x32x16_bf16 v[88:103], v[144:147], v[32:35], 0
  v_mfma_f32_32x32x16_bf16 v[88:103], v[148:151], v[36:39], v[88:103]
  s_nop 9
  v_add_f32_dpp v72, v73, v72 row_ror:8 row_mask:0x5 bank_mask:0xf
  v_add_f32_dpp v72, v75, v74 row_ror:8 row_mask:0xa bank_mask:0xf
  v_add_f32_dpp v76, v77, v76 row_ror:8 row_mask:0x5 bank_mask:0xf
  v_add_f32_dpp v76, v79, v78 row_ror:8 row_mask:0xa bank_mask:0xf
  v_add_f32_dpp v80, v81, v80 row_ror:8 row_mask:0x5 bank_mask:0xf
  v_add_f32_dpp v80, v83, v82 row_ror:8 row_mask:0xa bank_mask:0xf
  v_add_f32_dpp v84, v85, v84 row_ror:8 row_mask:0x5 bank_mask:0xf
  v_add_f32_dpp v84, v87, v86 row_ror:8 row_mask:0xa bank_mask:0xf
  s_nop 1
  v_permlane16_swap_b32 v72, v76
  v_permlane16_swap_b32 v80, v84
  v_add_f32 v16, v72, v76
  v_add_f32 v17, v80, v84
  v_mfma_f32_32x32x16_bf16 v[72:87], v[152:155], v[32:35], 0
  v_mfma_f32_32x32x16_bf16 v[72:87], v[156:159], v[36:39], v[72:87]
  v_add_f32_dpp v88, v89, v88 row_ror:8 row_mask:0x5 bank_mask:0xf
  v_add_f32_dpp v88, v91, v90 row_ror:8 row_mask:0xa bank_mask:0xf
  v_add_f32_dpp v92, v93, v92 row_ror:8 row_mask:0x5 bank_mask:0xf
  v_add_f32_dpp v92, v95, v94 row_ror:8 row_mask:0xa bank_mask:0xf
  v_add_f32_dpp v96, v97, v96 row_ror:8 row_mask:0x5 bank_mask:0xf
  v_add_f32_dpp v96, v99, v98 row_ror:8 row_mask:0xa bank_mask:0xf
  v_add_f32_dpp v100, v101, v100 row_ror:8 row_mask:0x5 bank_mask:0xf
  v_add_f32_dpp v100, v103, v102 row_ror:8 row_mask:0xa bank_mask:0xf
  s_nop 1
  v_permlane16_swap_b32 v88, v92
  v_permlane16_swap_b32 v96, v100
  v_add_f32 v18, v88, v92
  v_add_f32 v19, v96, v100
  v_mfma_f32_32x32x16_bf16 v[88:103], v[160:163], v[32:35], 0
  v_mfma_f32_32x32x16_bf16 v[88:103], v[164:167], v[36:39], v[88:103]
  v_add_f32_dpp v72, v73, v72 row_ror:8 row_mask:0x5 bank_mask:0xf
  v_add_f32_dpp v72, v75, v74 row_ror:8 row_mask:0xa bank_mask:0xf
  v_add_f32_dpp v76, v77, v76 row_ror:8 row_mask:0x5 bank_mask:0xf
  v_add_f32_dpp v76, v79, v78 row_ror:8 row_mask:0xa bank_mask:0xf
  v_add_f32_dpp v80, v81, v80 row_ror:8 row_mask:0x5 bank_mask:0xf
  v_add_f32_dpp v80, v83, v82 row_ror:8 row_mask:0xa bank_mask:0xf
  v_add_f32_dpp v84, v85, v84 row_ror:8 row_mask:0x5 bank_mask:0xf
  v_add_f32_dpp v84, v87, v86 row_ror:8 row_mask:0xa bank_mask:0xf
  s_nop 1
  v_permlane16_swap_b32 v72, v76
  v_permlane16_swap_b32 v80, v84
  v_add_f32 v20, v72, v76
  v_add_f32 v21, v80, v84
  v_add_f32_dpp v88, v89, v88 row_ror:8 row_mask:0x5 bank_mask:0xf
  v_add_f32_dpp v88, v91, v90 row_ror:8 row_mask:0xa bank_mask:0xf
  v_add_f32_dpp v92, v93, v92 row_ror:8 row_mask:0x5 bank_mask:0xf
  v_add_f32_dpp v92, v95, v94 row_ror:8 row_mask:0xa bank_mask:0xf
  v_add_f32_dpp v96, v97, v96 row_ror:8 row_mask:0x5 bank_mask:0xf
  v_add_f32_dpp v96, v99, v98 row_ror:8 row_mask:0xa bank_mask:0xf
  v_add_f32_dpp v100, v101, v100 row_ror:8 row_mask:0x5 bank_mask:0xf
  v_add_f32_dpp v100, v103, v102 row_ror:8 row_mask:0xa bank_mask:0xf
  s_nop 1
  v_permlane16_swap_b32 v88, v92
  v_permlane16_swap_b32 v96, v100
  v_add_f32 v22, v88, v92
  v_add_f32 v23, v96, v100
  s_bitcmp1_b32 s11, 9
  s_cbranch_scc1 L_t37
  s_bitcmp0_b32 s10, 9
  s_cbranch_scc1 L_t36
  s_waitcnt vmcnt(1)
L_t36:
  s_waitcnt vmcnt(2)
L_t37:
  s_waitcnt vmcnt(4)
  buffer_load_dwordx4 v[124:127], v4, s[20:23], s6 offen nt
  v_max3_f32 v8, v16, v17, v18
  v_max3_f32 v9, v19, v20, v21
  v_max3_f32 v8, v8, v22, v23
  v_max_f32 v8, v8, v9
  v_mov_b32 v9, v8
  s_nop 1
  v_permlane16_swap_b32 v9, v8
  v_max_f32 v8, v8, v9
  v_mov_b32 v9, v8
  s_nop 1
  v_permlane32_swap_b32 v9, v8
  v_max_f32 v8, v8, v9
  v_mul_f32 v8, s60, v8
  v_max_f32 v10, v5, v8
  v_sub_f32 v9, v5, v10
  v_exp_f32 v7, v9
  v_mov_b32 v5, v10
  v_fma_f32 v16, v16, s60, -v10
  v_fma_f32 v17, v17, s60, -v10
  v_fma_f32 v18, v18, s60, -v10
  v_fma_f32 v19, v19, s60, -v10
  v_fma_f32 v20, v20, s60, -v10
  v_fma_f32 v21, v21, s60, -v10
  v_fma_f32 v22, v22, s60, -v10
  v_fma_f32 v23, v23, s60, -v10
  v_exp_f32 v16, v16
  v_exp_f32 v17, v17
  v_exp_f32 v18, v18
  v_exp_f32 v19, v19
  v_exp_f32 v20, v20
  v_exp_f32 v21, v21
  v_exp_f32 v22, v22
  v_exp_f32 v23, v23
  v_mul_f32 v6, v6, v7
  v_cvt_pk_bf16_f32 v12, v16, v17
  v_cvt_pk_bf16_f32 v13, v18, v19
  v_cvt_pk_bf16_f32 v14, v20, v21
  v_cvt_pk_bf16_f32 v15, v22, v23
  v_add_f32 v8, v16, v17
  v_add_f32 v9, v18, v19
  v_add_f32 v20, v20, v21
  v_add_f32 v22, v22, v23
  v_add_f32 v8, v8, v9
  v_add_f32 v20, v20, v22
  v_add_f32 v6, v6, v8
  v_add_f32 v6, v6, v20
  v_mov_b32_dpp v7, v7 row_ror:8 row_mask:0xf bank_mask:0xc
  s_mov_b64 exec, s[70:71]
  ds_write_b128 v40, v[12:15]
  s_mov_b64 exec, -1
  v_cndmask_b32 v253, v253, v7, s[0:1]
  s_lshl_b64 s[0:1], s[0:1], 8
  v_add_u32 v40, 512, v40
  s_bitcmp1_b32 0x88, s73
  s_cbranch_scc1 L_hookK
L_kback:
  s_bitcmp1_b32 s11, 10
  s_cbranch_scc1 L_t39
  s_bitcmp0_b32 s10, 10
  s_cbranch_scc1 L_t38
  s_waitcnt vmcnt(1)
L_t38:
  s_waitcnt vmcnt(2)
L_t39:
  s_waitcnt vmcnt(4)
  buffer_load_dwordx4 v[128:131], v2, s[20:23], s7 offen nt
  s_bitcmp1_b32 s11, 11
  s_cbranch_scc1 L_t41
  s_bitcmp0_b32 s10, 11
  s_cbranch_scc1 L_t40
  s_waitcnt vmcnt(1)
L_t40:
  s_waitcnt vmcnt(2)
L_t41:
  s_waitcnt vmcnt(4)
  buffer_load_dwordx4 v[132:135], v4, s[20:23], s7 offen nt
  s_cmp_eq_u32 s31, 0
  s_cbranch_scc1 L_knext2
L_wsnip:
  v_and_b32 v8, 15, v11
  v_lshlrev_b32 v8, 3, v8
  v_lshrrev_b32 v9, 5, v11
  v_lshl_add_u32 v8, v9, 7, v8
  v_bfe_u32 v9, v11, 4, 1
  v_lshl_add_u32 v8, v9, 8, v8
  v_add_u32 v8, s68, v8
  ds_read2st64_b64 v[72:75], v8 offset0:0 offset1:8
  ds_read2st64_b64 v[76:79], v8 offset0:2 offset1:10
  ds_read2st64_b64 v[80:83], v8 offset0:4 offset1:12
  ds_read2st64_b64 v[84:87], v8 offset0:6 offset1:14
  ds_read2st64_b64 v[88:91], v8 offset0:1 offset1:9
  ds_read2st64_b64 v[92:95], v8 offset0:3 offset1:11
  ds_read2st64_b64 v[96:99], v8 offset0:5 offset1:13
  ds_read2st64_b64 v[100:103], v8 offset0:7 offset1:15
  s_cmp_eq_u32 s30, 2
  s_cbranch_scc1 L_s1
  s_waitcnt lgkmcnt(0)
  v_perm_b32 v168, v76, v72, s58
  v_perm_b32 v169, v84, v80, s58
  v_perm_b32 v170, v92, v88, s58
  v_perm_b32 v171, v100, v96, s58
  v_perm_b32 v172, v76, v72, s59
  v_perm_b32 v173, v84, v80, s59
  v_perm_b32 v174, v92, v88, s59
  v_perm_b32 v175, v100, v96, s59
  v_perm_b32 v176, v77, v73, s58
  v_perm_b32 v177, v85, v81, s58
  v_perm_b32 v178, v93, v89, s58
  v_perm_b32 v179, v101, v97, s58
  v_perm_b32 v180, v77, v73, s59
  v_perm_b32 v181, v85, v81, s59
  v_perm_b32 v182, v93, v89, s59
  v_perm_b32 v183, v101, v97, s59
  v_perm_b32 v184, v78, v74, s58
  v_perm_b32 v185, v86, v82, s58
  v_perm_b32 v186, v94, v90, s58
  v_perm_b32 v187, v102, v98, s58
  v_perm_b32 v188, v78, v74, s59
  v_perm_b32 v189, v86, v82, s59
  v_perm_b32 v190, v94, v90, s59
  v_perm_b32 v191, v102, v98, s59
  v_perm_b32 v192, v79, v75, s58
  v_perm_b32 v193, v87, v83, s58
  v_perm_b32 v194, v95, v91, s58
  v_perm_b32 v195, v103, v99, s58
  v_perm_b32 v196, v79, v75, s59
  v_perm_b32 v197, v87, v83, s59
  v_perm_b32 v198, v95, v91, s59
  v_perm_b32 v199, v103, v99, s59
  s_branch L_knext
L_s1:
  s_waitcnt lgkmcnt(0)
  v_perm_b32 v200, v76, v72, s58
  v_perm_b32 v201, v84, v80, s58
  v_perm_b32 v202, v92, v88, s58
  v_perm_b32 v203, v100, v96, s58
  v_perm_b32 v204, v76, v72, s59
  v_perm_b32 v205, v84, v80, s59
  v_perm_b32 v206, v92, v88, s59
  v_perm_b32 v207, v100, v96, s59
  v_perm_b32 v208, v77, v73, s58
  v_perm_b32 v209, v85, v81, s58
  v_perm_b32 v210, v93, v89, s58
  v_perm_b32 v211, v101, v97, s58
  v_perm_b32 v212, v77, v73, s59
  v_perm_b32 v213, v85, v81, s59
  v_perm_b32 v214, v93, v89, s59
  v_perm_b32 v215, v101, v97, s59
  v_perm_b32 v216, v78, v74, s58
  v_perm_b32 v217, v86, v82, s58
  v_perm_b32 v218, v94, v90, s58
  v_perm_b32 v219, v102, v98, s58
  v_perm_b32 v220, v78, v74, s59
  v_perm_b32 v221, v86, v82, s59
  v_perm_b32 v222, v94, v90, s59
  v_perm_b32 v223, v102, v98, s59
  v_perm_b32 v224, v79, v75, s58
  v_perm_b32 v225, v87, v83, s58
  v_perm_b32 v226, v95, v91, s58
  v_perm_b32 v227, v103, v99, s58
  v_perm_b32 v228, v79, v75, s59
  v_perm_b32 v229, v87, v83, s59
  v_perm_b32 v230, v95, v91, s59
  v_perm_b32 v231, v103, v99, s59
L_knext:
L_knext2:
  s_cmp_lt_u32 s73, 7
  s_cbranch_scc1 L_top
  v_mov_b32 v40, 0
  v_mov_b32 v41, 0
  v_mov_b32 v42, 0
  v_mov_b32 v43, 0
  v_mov_b32 v44, 0
  v_mov_b32 v45, 0
  v_mov_b32 v46, 0
  v_mov_b32 v47, 0
  v_mov_b32 v48, 0
  v_mov_b32 v49, 0
  v_mov_b32 v50, 0
  v_mov_b32 v51, 0
  v_mov_b32 v52, 0
  v_mov_b32 v53, 0
  v_mov_b32 v54, 0
  v_mov_b32 v55, 0
  v_mov_b32 v56, 0
  v_mov_b32 v57, 0
  v_mov_b32 v58, 0
  v_mov_b32 v59, 0
  v_mov_b32 v60, 0
  v_mov_b32 v61, 0
  v_mov_b32 v62, 0
  v_mov_b32 v63, 0
  v_mov_b32 v64, 0
  v_mov_b32 v65, 0
  v_mov_b32 v66, 0
  v_mov_b32 v67, 0
  v_mov_b32 v68, 0
  v_mov_b32 v69, 0
  v_mov_b32 v70, 0
  v_mov_b32 v71, 0
  v_lshrrev_b32 v9, 4, v11
  v_and_b32 v8, 7, v11
  v_lshlrev_b32 v9, 7, v9
  v_lshl_add_u32 v9, v8, 4, v9
  s_lshl_b32 s61, s52, 12
  v_add_u32 v32, s61, v9
  v_lshlrev_b32 v33, 2, v8
L_vtop:
  ds_read_b128 v[12:15], v32
  ds_bpermute_b32 v7, v33, v254
  v_add_u32 v32, 512, v32
  v_add_u32 v33, 32, v33
  s_memrealtime s[8:9]
  s_cmp_lt_u32 s73, 3
  s_cbranch_scc1 L_nosmpv
  s_cmp_lt_u32 s14, 16
  s_cbranch_scc1 L_nosmpv
  s_cmp_ge_u32 s73, 14
  s_cbranch_scc1 L_nosmpv
  s_lshl_b32 s61, s73, 11
  s_add_u32 s61, s61, 3178496
  s_add_u32 s76, s18, s61
  s_addc_u32 s77, s19, 0
  s_load_dword s80, s[76:77], 0
  s_load_dword s81, s[76:77], 128
  s_load_dword s82, s[76:77], 256
  s_load_dword s83, s[76:77], 384
  s_load_dword s84, s[76:77], 512
  s_load_dword s85, s[76:77], 640
  s_load_dword s86, s[76:77], 768
  s_load_dword s87, s[76:77], 896
  s_load_dword s88, s[76:77], 1024
  s_load_dword s89, s[76:77], 1152
  s_load_dword s90, s[76:77], 1280
  s_load_dword s91, s[76:77], 1408
  s_load_dword s92, s[76:77], 1536
  s_load_dword s93, s[76:77], 1664
  s_load_dword s94, s[76:77], 1792
  s_load_dword s95, s[76:77], 1920
L_nosmpv:
  s_add_u32 s73, s73, 1
  s_add_u32 s56, s56, 1
  s_and_b32 s57, s56, 8
  s_lshl_b32 s57, s57, 21
  s_add_u32 s57, s57, s74
  s_add_u32 s75, s75, 1
  s_bfe_u32 s64, s75, 0x10000
  s_lshl_b32 s64, s64, 10
  s_add_u32 s57, s57, s64
  s_bfe_u32 s64, s75, 0x10001
  s_lshl_b32 s64, s64, 18
  s_add_u32 s57, s57, s64
  s_bfe_u32 s64, s75, 0x10002
  s_lshl_b32 s64, s64, 14
  s_add_u32 s57, s57, s64
  s_add_u32 s4, s57, s96
  s_add_u32 s5, s57, s97
  s_add_u32 s6, s57, s98
  s_add_u32 s7, s57, s99
  s_cmp_eq_u32 s73, 15
  s_cbranch_scc1 L_egB
L_egB0:
  s_cmp_eq_u32 s10, 0
  s_cselect_b32 s61, 15, 99
  s_cmp_eq_u32 s73, s61
  s_cbranch_scc1 L_lastA
  s_cmp_ge_u32 s73, 15
  s_cselect_b32 s11, -1, s11
L_egB1:
  s_bitcmp1_b32 s11, 12
  s_cbranch_scc1 L_t43
  s_bitcmp0_b32 s10, 12
  s_cbranch_scc1 L_t42
  s_waitcnt vmcnt(1)
L_t42:
  s_waitcnt vmcnt(2)
L_t43:
  s_waitcnt vmcnt(4)
  buffer_load_dwordx4 v[136:139], v2, s[24:27], s4 offen nt
  s_bitcmp1_b32 s11, 13
  s_cbranch_scc1 L_t45
  s_bitcmp0_b32 s10, 13
  s_cbranch_scc1 L_t44
  s_waitcnt vmcnt(1)
L_t44:
  s_waitcnt vmcnt(2)
L_t45:
  s_waitcnt vmcnt(4)
  buffer_load_dwordx4 v[140:143], v4, s[24:27], s4 offen nt
  s_bitcmp1_b32 s11, 14
  s_cbranch_scc1 L_t47
  s_bitcmp0_b32 s10, 14
  s_cbranch_scc1 L_t46
  s_waitcnt vmcnt(1)
L_t46:
  s_waitcnt vmcnt(2)
L_t47:
  s_waitcnt vmcnt(4)
  buffer_load_dwordx4 v[144:147], v2, s[24:27], s5 offen nt
  s_bitcmp1_b32 s11, 15
  s_cbranch_scc1 L_t49
  s_bitcmp0_b32 s10, 15
  s_cbranch_scc1 L_t48
  s_waitcnt vmcnt(1)
L_t48:
  s_waitcnt vmcnt(2)
L_t49:
  s_waitcnt vmcnt(4)
  buffer_load_dwordx4 v[148:151], v4, s[24:27], s5 offen nt
  s_waitcnt lgkmcnt(0)
  s_min_u32 s8, s8, -2
  s_and_b32 s61, s73, 7
  s_cmp_lg_u32 s15, s61
  s_cbranch_scc1 L_nopubv
  s_cmp_ge_u32 s73, 14
  s_cbranch_scc1 L_nopubv
  s_lshl_b32 s61, s73, 11
  s_add_u32 s61, s61, s35
  v_mov_b32 v8, s8
  s_mov_b64 exec, 1
  buffer_store_dword v8, off, s[40:43], s61 sc1
  s_mov_b64 exec, -1
L_nopubv:
  s_cmp_lt_u32 s73, 4
  s_cbranch_scc1 L_nolvlv
  s_cmp_lt_u32 s14, 16
  s_cbranch_scc1 L_nolvlv
  s_cmp_gt_u32 s73, 14
  s_cbranch_scc1 L_nolvlv
  s_mov_b32 s61, 0
  s_sub_u32 s62, s8, s80
  s_cmp_lt_u32 s62, 2000
  s_cselect_b32 s62, s62, 0
  s_add_u32 s61, s61, s62
  s_sub_u32 s62, s8, s81
  s_cmp_lt_u32 s62, 2000
  s_cselect_b32 s62, s62, 0
  s_add_u32 s61, s61, s62
  s_sub_u32 s62, s8, s82
  s_cmp_lt_u32 s62, 2000
  s_cselect_b32 s62, s62, 0
  s_add_u32 s61, s61, s62
  s_sub_u32 s62, s8, s83
  s_cmp_lt_u32 s62, 2000
  s_cselect_b32 s62, s62, 0
  s_add_u32 s61, s61, s62
  s_sub_u32 s62, s8, s84
  s_cmp_lt_u32 s62, 2000
  s_cselect_b32 s62, s62, 0
  s_add_u32 s61, s61, s62
  s_sub_u32 s62, s8, s85
  s_cmp_lt_u32 s62, 2000
  s_cselect_b32 s62, s62, 0
  s_add_u32 s61, s61, s62
  s_sub_u32 s62, s8, s86
  s_cmp_lt_u32 s62, 2000
  s_cselect_b32 s62, s62, 0
  s_add_u32 s61, s61, s62
  s_sub_u32 s62, s8, s87
  s_cmp_lt_u32 s62, 2000
  s_cselect_b32 s62, s62, 0
  s_add_u32 s61, s61, s62
  s_sub_u32 s62, s8, s88
  s_cmp_lt_u32 s62, 2000
  s_cselect_b32 s62, s62, 0
  s_add_u32 s61, s61, s62
  s_sub_u32 s62, s8, s89
  s_cmp_lt_u32 s62, 2000
  s_cselect_b32 s62, s62, 0
  s_add_u32 s61, s61, s62
  s_sub_u32 s62, s8, s90
  s_cmp_lt_u32 s62, 2000
  s_cselect_b32 s62, s62, 0
  s_add_u32 s61, s61, s62
  s_sub_u32 s62, s8, s91
  s_cmp_lt_u32 s62, 2000
  s_cselect_b32 s62, s62, 0
  s_add_u32 s61, s61, s62
  s_sub_u32 s62, s8, s92
  s_cmp_lt_u32 s62, 2000
  s_cselect_b32 s62, s62, 0
  s_add_u32 s61, s61, s62
  s_sub_u32 s62, s8, s93
  s_cmp_lt_u32 s62, 2000
  s_cselect_b32 s62, s62, 0
  s_add_u32 s61, s61, s62
  s_sub_u32 s62, s8, s94
  s_cmp_lt_u32 s62, 2000
  s_cselect_b32 s62, s62, 0
  s_add_u32 s61, s61, s62
  s_sub_u32 s62, s8, s95
  s_cmp_lt_u32 s62, 2000
  s_cselect_b32 s62, s62, 0
  s_add_u32 s61, s61, s62
  s_lshr_b32 s61, s61, 4
  s_sub_u32 s61, s8, s61
  s_cmp_eq_u32 s73, 10
  s_cselect_b32 s30, s61, s30
  s_mov_b32 s31, s61
  s_add_u32 s61, s61, s12
  s_sub_u32 s61, s13, s61
  s_mul_i32 s61, s61, 8
  s_ashr_i32 s61, s61, 7
  s_sub_i32 s61, 2, s61
  s_max_i32 s62, s61, 0
  s_min_i32 s62, s62, 16
  s_sub_i32 s61, 0, s61
  s_max_i32 s61, s61, 0
  s_mul_i32 s61, s61, 2
  s_add_u32 s61, s61, 1
  s_lshr_b32 s61, s61, 1
  s_min_i32 s61, s61, 16
  s_add_u32 s13, s8, s12
  s_bfm_b32 s11, s61, 0
  s_bfm_b32 s10, s62, 0
  s_mul_i32 s61, s61, 4
  s_add_u32 s12, s12, s61
  s_sub_i32 s62, 2, s62
  s_mul_i32 s62, s62, 12
  s_add_u32 s12, s12, s62
  s_branch L_lvdv
L_nolvlv:
  s_add_u32 s13, s8, s12
L_lvdv:
  v_mul_f32 v40, v40, v7
  v_mul_f32 v41, v41, v7
  v_mul_f32 v42, v42, v7
  v_mul_f32 v43, v43, v7
  v_mul_f32 v44, v44, v7
  v_mul_f32 v45, v45, v7
  v_mul_f32 v46, v46, v7
  v_mul_f32 v47, v47, v7
  v_mul_f32 v48, v48, v7
  v_mul_f32 v49, v49, v7
  v_mul_f32 v50, v50, v7
  v_mul_f32 v51, v51, v7
  v_mul_f32 v52, v52, v7
  v_mul_f32 v53, v53, v7
  v_mul_f32 v54, v54, v7
  v_mul_f32 v55, v55, v7
  v_mul_f32 v56, v56, v7
  v_mul_f32 v57, v57, v7
  v_mul_f32 v58, v58, v7
  v_mul_f32 v59, v59, v7
  v_mul_f32 v60, v60, v7
  v_mul_f32 v61, v61, v7
  v_mul_f32 v62, v62, v7
  v_mul_f32 v63, v63, v7
  v_mul_f32 v64, v64, v7
  v_mul_f32 v65, v65, v7
  v_mul_f32 v66, v66, v7
  v_mul_f32 v67, v67, v7
  v_mul_f32 v68, v68, v7
  v_mul_f32 v69, v69, v7
  v_mul_f32 v70, v70, v7
  v_mul_f32 v71, v71, v7
  s_bitcmp1_b32 s11, 0
  s_cbranch_scc1 L_t51
  s_bitcmp0_b32 s10, 0
  s_cbranch_scc1 L_t50
  s_waitcnt vmcnt(1)
L_t50:
  s_waitcnt vmcnt(2)
L_t51:
  s_waitcnt vmcnt(4)
  buffer_load_dwordx4 v[152:155], v2, s[24:27], s6 offen nt
  v_perm_b32 v24, v108, v104, s58
  v_perm_b32 v25, v116, v112, s58
  v_perm_b32 v26, v124, v120, s58
  v_perm_b32 v27, v132, v128, s58
  v_perm_b32 v28, v108, v104, s59
  v_perm_b32 v29, v116, v112, s59
  v_perm_b32 v30, v124, v120, s59
  v_perm_b32 v31, v132, v128, s59
  v_mfma_f32_16x16x32_bf16 v[40:43], v[24:27], v[12:15], v[40:43]
  v_perm_b32 v24, v109, v105, s58
  v_perm_b32 v25, v117, v113, s58
  v_perm_b32 v26, v125, v121, s58
  v_perm_b32 v27, v133, v129, s58
  v_mfma_f32_16x16x32_bf16 v[44:47], v[28:31], v[12:15], v[44:47]
  v_perm_b32 v28, v109, v105, s59
  v_perm_b32 v29, v117, v113, s59
  v_perm_b32 v30, v125, v121, s59
  v_perm_b32 v31, v133, v129, s59
  v_mfma_f32_16x16x32_bf16 v[48:51], v[24:27], v[12:15], v[48:51]
  v_perm_b32 v24, v110, v106, s58
  v_perm_b32 v25, v118, v114, s58
  v_perm_b32 v26, v126, v122, s58
  v_perm_b32 v27, v134, v130, s58
  v_mfma_f32_16x16x32_bf16 v[52:55], v[28:31], v[12:15], v[52:55]
  v_perm_b32 v28, v110, v106, s59
  v_perm_b32 v29, v118, v114, s59
  v_perm_b32 v30, v126, v122, s59
  v_perm_b32 v31, v134, v130, s59
  v_mfma_f32_16x16x32_bf16 v[56:59], v[24:27], v[12:15], v[56:59]
  v_perm_b32 v24, v111, v107, s58
  v_perm_b32 v25, v119, v115, s58
  v_perm_b32 v26, v127, v123, s58
  v_perm_b32 v27, v135, v131, s58
  v_mfma_f32_16x16x32_bf16 v[60:63], v[28:31], v[12:15], v[60:63]
  v_perm_b32 v28, v111, v107, s59
  v_perm_b32 v29, v119, v115, s59
  v_perm_b32 v30, v127, v123, s59
  v_perm_b32 v31, v135, v131, s59
  v_mfma_f32_16x16x32_bf16 v[64:67], v[24:27], v[12:15], v[64:67]
  s_nop 1
  v_mfma_f32_16x16x32_bf16 v[68:71], v[28:31], v[12:15], v[68:71]
  s_bitcmp1_b32 s11, 1
  s_cbranch_scc1 L_t53
  s_bitcmp0_b32 s10, 1
  s_cbranch_scc1 L_t52
  s_waitcnt vmcnt(1)
L_t52:
  s_waitcnt vmcnt(2)
L_t53:
  s_waitcnt vmcnt(4)
  buffer_load_dwordx4 v[156:159], v4, s[24:27], s6 offen nt
  s_bitcmp1_b32 s11, 2
  s_cbranch_scc1 L_t55
  s_bitcmp0_b32 s10, 2
  s_cbranch_scc1 L_t54
  s_waitcnt vmcnt(1)
L_t54:
  s_waitcnt vmcnt(2)
L_t55:
  s_waitcnt vmcnt(4)
  buffer_load_dwordx4 v[160:163], v2, s[24:27], s7 offen nt
  s_bitcmp1_b32 s11, 3
  s_cbranch_scc1 L_t57
  s_bitcmp0_b32 s10, 3
  s_cbranch_scc1 L_t56
  s_waitcnt vmcnt(1)
L_t56:
  s_waitcnt vmcnt(2)
L_t57:
  s_waitcnt vmcnt(4)
  buffer_load_dwordx4 v[164:167], v4, s[24:27], s7 offen nt
  ds_read_b128 v[12:15], v32
  ds_bpermute_b32 v7, v33, v254
  v_add_u32 v32, 512, v32
  v_add_u32 v33, 32, v33
  s_cmp_eq_u32 s73, 15
  s_cbranch_scc1 L_last
  s_cmp_eq_u32 s73, 14
  s_cbranch_scc1 L_egA
L_egA0:
  s_add_u32 s56, s56, 1
  s_and_b32 s57, s56, 8
  s_lshl_b32 s57, s57, 21
  s_add_u32 s57, s57, s74
  s_add_u32 s75, s75, 1
  s_bfe_u32 s64, s75, 0x10000
  s_lshl_b32 s64, s64, 10
  s_add_u32 s57, s57, s64
  s_bfe_u32 s64, s75, 0x10001
  s_lshl_b32 s64, s64, 18
  s_add_u32 s57, s57, s64
  s_bfe_u32 s64, s75, 0x10002
  s_lshl_b32 s64, s64, 14
  s_add_u32 s57, s57, s64
  s_add_u32 s4, s57, s96
  s_add_u32 s5, s57, s97
  s_add_u32 s6, s57, s98
  s_add_u32 s7, s57, s99
  s_bitcmp1_b32 s11, 4
  s_cbranch_scc1 L_t59
  s_bitcmp0_b32 s10, 4
  s_cbranch_scc1 L_t58
  s_waitcnt vmcnt(1)
L_t58:
  s_waitcnt vmcnt(2)
L_t59:
  s_waitcnt vmcnt(4)
  buffer_load_dwordx4 v[104:107], v2, s[24:27], s4 offen nt
  s_bitcmp1_b32 s11, 5
  s_cbranch_scc1 L_t61
  s_bitcmp0_b32 s10, 5
  s_cbranch_scc1 L_t60
  s_waitcnt vmcnt(1)
L_t60:
  s_waitcnt vmcnt(2)
L_t61:
  s_waitcnt vmcnt(4)
  buffer_load_dwordx4 v[108:111], v4, s[24:27], s4 offen nt
  s_waitcnt lgkmcnt(0)
  v_mul_f32 v40, v40, v7
  v_mul_f32 v41, v41, v7
  v_mul_f32 v42, v42, v7
  v_mul_f32 v43, v43, v7
  v_mul_f32 v44, v44, v7
  v_mul_f32 v45, v45, v7
  v_mul_f32 v46, v46, v7
  v_mul_f32 v47, v47, v7
  v_mul_f32 v48, v48, v7
  v_mul_f32 v49, v49, v7
  v_mul_f32 v50, v50, v7
  v_mul_f32 v51, v51, v7
  v_mul_f32 v52, v52, v7
  v_mul_f32 v53, v53, v7
  v_mul_f32 v54, v54, v7
  v_mul_f32 v55, v55, v7
  v_mul_f32 v56, v56, v7
  v_mul_f32 v57, v57, v7
  v_mul_f32 v58, v58, v7
  v_mul_f32 v59, v59, v7
  v_mul_f32 v60, v60, v7
  v_mul_f32 v61, v61, v7
  v_mul_f32 v62, v62, v7
  v_mul_f32 v63, v63, v7
  v_mul_f32 v64, v64, v7
  v_mul_f32 v65, v65, v7
  v_mul_f32 v66, v66, v7
  v_mul_f32 v67, v67, v7
  v_mul_f32 v68, v68, v7
  v_mul_f32 v69, v69, v7
  v_mul_f32 v70, v70, v7
  v_mul_f32 v71, v71, v7
  s_bitcmp1_b32 s11, 6
  s_cbranch_scc1 L_t63
  s_bitcmp0_b32 s10, 6
  s_cbranch_scc1 L_t62
  s_waitcnt vmcnt(1)
L_t62:
  s_waitcnt vmcnt(2)
L_t63:
  s_waitcnt vmcnt(4)
  buffer_load_dwordx4 v[112:115], v2, s[24:27], s5 offen nt
  s_bitcmp1_b32 s11, 7
  s_cbranch_scc1 L_t65
  s_bitcmp0_b32 s10, 7
  s_cbranch_scc1 L_t64
  s_waitcnt vmcnt(1)
L_t64:
  s_waitcnt vmcnt(2)
L_t65:
  s_waitcnt vmcnt(4)
  buffer_load_dwordx4 v[116:119], v4, s[24:27], s5 offen nt
  s_bitcmp1_b32 s11, 8
  s_cbranch_scc1 L_t67
  s_bitcmp0_b32 s10, 8
  s_cbranch_scc1 L_t66
  s_waitcnt vmcnt(1)
L_t66:
  s_waitcnt vmcnt(2)
L_t67:
  s_waitcnt vmcnt(4)
  buffer_load_dwordx4 v[120:123], v2, s[24:27], s6 offen nt
  s_cmp_eq_u32 s73, 11
  s_cbranch_scc1 L_pvf
  v_perm_b32 v24, v140, v136, s58
  v_perm_b32 v25, v148, v144, s58
  v_perm_b32 v26, v156, v152, s58
  v_perm_b32 v27, v164, v160, s58
  v_perm_b32 v28, v140, v136, s59
  v_perm_b32 v29, v148, v144, s59
  v_perm_b32 v30, v156, v152, s59
  v_perm_b32 v31, v164, v160, s59
  v_mfma_f32_16x16x32_bf16 v[40:43], v[24:27], v[12:15], v[40:43]
  v_perm_b32 v24, v141, v137, s58
  v_perm_b32 v25, v149, v145, s58
  v_perm_b32 v26, v157, v153, s58
  v_perm_b32 v27, v165, v161, s58
  v_mfma_f32_16x16x32_bf16 v[44:47], v[28:31], v[12:15], v[44:47]
  v_perm_b32 v28, v141, v137, s59
  v_perm_b32 v29, v149, v145, s59
  v_perm_b32 v30, v157, v153, s59
  v_perm_b32 v31, v165, v161, s59
  v_mfma_f32_16x16x32_bf16 v[48:51], v[24:27], v[12:15], v[48:51]
  v_perm_b32 v24, v142, v138, s58
  v_perm_b32 v25, v150, v146, s58
  v_perm_b32 v26, v158, v154, s58
  v_perm_b32 v27, v166, v162, s58
  v_mfma_f32_16x16x32_bf16 v[52:55], v[28:31], v[12:15], v[52:55]
  v_perm_b32 v28, v142, v138, s59
  v_perm_b32 v29, v150, v146, s59
  v_perm_b32 v30, v158, v154, s59
  v_perm_b32 v31, v166, v162, s59
  v_mfma_f32_16x16x32_bf16 v[56:59], v[24:27], v[12:15], v[56:59]
  v_perm_b32 v24, v143, v139, s58
  v_perm_b32 v25, v151, v147, s58
  v_perm_b32 v26, v159, v155, s58
  v_perm_b32 v27, v167, v163, s58
  v_mfma_f32_16x16x32_bf16 v[60:63], v[28:31], v[12:15], v[60:63]
  v_perm_b32 v28, v143, v139, s59
  v_perm_b32 v29, v151, v147, s59
  v_perm_b32 v30, v159, v155, s59
  v_perm_b32 v31, v167, v163, s59
  v_mfma_f32_16x16x32_bf16 v[64:67], v[24:27], v[12:15], v[64:67]
  s_nop 1
  v_mfma_f32_16x16x32_bf16 v[68:71], v[28:31], v[12:15], v[68:71]
  s_cmp_eq_u32 s73, 10
  s_cbranch_scc1 L_hookC
L_hpb:
L_krest:
  s_bitcmp1_b32 s11, 9
  s_cbranch_scc1 L_t69
  s_bitcmp0_b32 s10, 9
  s_cbranch_scc1 L_t68
  s_waitcnt vmcnt(1)
L_t68:
  s_waitcnt vmcnt(2)
L_t69:
  s_waitcnt vmcnt(4)
  buffer_load_dwordx4 v[124:127], v4, s[24:27], s6 offen nt
  s_bitcmp1_b32 s11, 10
  s_cbranch_scc1 L_t71
  s_bitcmp0_b32 s10, 10
  s_cbranch_scc1 L_t70
  s_waitcnt vmcnt(1)
L_t70:
  s_waitcnt vmcnt(2)
L_t71:
  s_waitcnt vmcnt(4)
  buffer_load_dwordx4 v[128:131], v2, s[24:27], s7 offen nt
  s_bitcmp1_b32 s11, 11
  s_cbranch_scc1 L_t73
  s_bitcmp0_b32 s10, 11
  s_cbranch_scc1 L_t72
  s_waitcnt vmcnt(1)
L_t72:
  s_waitcnt vmcnt(2)
L_t73:
  s_waitcnt vmcnt(4)
  buffer_load_dwordx4 v[132:135], v4, s[24:27], s7 offen nt
  s_branch L_vtop
L_egA:
  s_cmp_lt_u32 s14, 16
  s_cbranch_scc1 L_egA0
  s_memrealtime s[8:9]
  s_sub_u32 s30, s31, s30
  s_lshr_b32 s30, s30, 3
  s_mul_i32 s61, s30, 3
  s_add_u32 s31, s31, s61
  s_waitcnt lgkmcnt(0)
  s_sub_u32 s61, s8, s31
  s_add_u32 s31, s31, s30
  s_cmp_gt_i32 s61, 150
  s_cbranch_scc1 L_egS
  s_mul_i32 s61, s61, 16
  s_ashr_i32 s61, s61, 7
  s_sub_i32 s61, 2, s61
  s_max_i32 s62, s61, 0
  s_min_i32 s62, s62, 8
  s_sub_i32 s61, 0, s61
  s_max_i32 s61, s61, 0
  s_min_i32 s61, s61, 8
  s_bfm_b32 s11, s61, 4
  s_bfm_b32 s10, s62, 4
  s_branch L_egA0
L_egS:
  s_add_u32 s56, s56, 1
  s_and_b32 s57, s56, 8
  s_lshl_b32 s57, s57, 21
  s_add_u32 s57, s57, s74
  s_add_u32 s75, s75, 1
  s_bfe_u32 s64, s75, 0x10000
  s_lshl_b32 s64, s64, 10
  s_add_u32 s57, s57, s64
  s_bfe_u32 s64, s75, 0x10001
  s_lshl_b32 s64, s64, 18
  s_add_u32 s57, s57, s64
  s_bfe_u32 s64, s75, 0x10002
  s_lshl_b32 s64, s64, 14
  s_add_u32 s57, s57, s64
  s_add_u32 s4, s57, s96
  s_add_u32 s5, s57, s97
  s_add_u32 s6, s57, s98
  s_add_u32 s7, s57, s99
  buffer_load_dwordx4 v[104:107], v2, s[24:27], s4 offen nt
  buffer_load_dwordx4 v[108:111], v4, s[24:27], s4 offen nt
  buffer_load_dwordx4 v[112:115], v2, s[24:27], s5 offen nt
  buffer_load_dwordx4 v[116:119], v4, s[24:27], s5 offen nt
  buffer_load_dwordx4 v[120:123], v2, s[24:27], s6 offen nt
  buffer_load_dwordx4 v[124:127], v4, s[24:27], s6 offen nt
  buffer_load_dwordx4 v[128:131], v2, s[24:27], s7 offen nt
  buffer_load_dwordx4 v[132:135], v4, s[24:27], s7 offen nt
  s_sub_u32 s31, s31, 0x4000
  v_mul_f32 v40, v40, v7
  v_mul_f32 v41, v41, v7
  v_mul_f32 v42, v42, v7
  v_mul_f32 v43, v43, v7
  v_mul_f32 v44, v44, v7
  v_mul_f32 v45, v45, v7
  v_mul_f32 v46, v46, v7
  v_mul_f32 v47, v47, v7
  v_mul_f32 v48, v48, v7
  v_mul_f32 v49, v49, v7
  v_mul_f32 v50, v50, v7
  v_mul_f32 v51, v51, v7
  v_mul_f32 v52, v52, v7
  v_mul_f32 v53, v53, v7
  v_mul_f32 v54, v54, v7
  v_mul_f32 v55, v55, v7
  v_mul_f32 v56, v56, v7
  v_mul_f32 v57, v57, v7
  v_mul_f32 v58, v58, v7
  v_mul_f32 v59, v59, v7
  v_mul_f32 v60, v60, v7
  v_mul_f32 v61, v61, v7
  v_mul_f32 v62, v62, v7
  v_mul_f32 v63, v63, v7
  v_mul_f32 v64, v64, v7
  v_mul_f32 v65, v65, v7
  v_mul_f32 v66, v66, v7
  v_mul_f32 v67, v67, v7
  v_mul_f32 v68, v68, v7
  v_mul_f32 v69, v69, v7
  v_mul_f32 v70, v70, v7
  v_mul_f32 v71, v71, v7
  s_waitcnt vmcnt(8)
  v_perm_b32 v24, v140, v136, s58
  v_perm_b32 v25, v148, v144, s58
  v_perm_b32 v26, v156, v152, s58
  v_perm_b32 v27, v164, v160, s58
  v_perm_b32 v28, v140, v136, s59
  v_perm_b32 v29, v148, v144, s59
  v_perm_b32 v30, v156, v152, s59
  v_perm_b32 v31, v164, v160, s59
  v_mfma_f32_16x16x32_bf16 v[40:43], v[24:27], v[12:15], v[40:43]
  v_perm_b32 v24, v141, v137, s58
  v_perm_b32 v25, v149, v145, s58
  v_perm_b32 v26, v157, v153, s58
  v_perm_b32 v27, v165, v161, s58
  v_mfma_f32_16x16x32_bf16 v[44:47], v[28:31], v[12:15], v[44:47]
  v_perm_b32 v28, v141, v137, s59
  v_perm_b32 v29, v149, v145, s59
  v_perm_b32 v30, v157, v153, s59
  v_perm_b32 v31, v165, v161, s59
  v_mfma_f32_16x16x32_bf16 v[48:51], v[24:27], v[12:15], v[48:51]
  v_perm_b32 v24, v142, v138, s58
  v_perm_b32 v25, v150, v146, s58
  v_perm_b32 v26, v158, v154, s58
  v_perm_b32 v27, v166, v162, s58
  v_mfma_f32_16x16x32_bf16 v[52:55], v[28:31], v[12:15], v[52:55]
  v_perm_b32 v28, v142, v138, s59
  v_perm_b32 v29, v150, v146, s59
  v_perm_b32 v30, v158, v154, s59
  v_perm_b32 v31, v166, v162, s59
  v_mfma_f32_16x16x32_bf16 v[56:59], v[24:27], v[12:15], v[56:59]
  v_perm_b32 v24, v143, v139, s58
  v_perm_b32 v25, v151, v147, s58
  v_perm_b32 v26, v159, v155, s58
  v_perm_b32 v27, v167, v163, s58
  v_mfma_f32_16x16x32_bf16 v[60:63], v[28:31], v[12:15], v[60:63]
  v_perm_b32 v28, v143, v139, s59
  v_perm_b32 v29, v151, v147, s59
  v_perm_b32 v30, v159, v155, s59
  v_perm_b32 v31, v167, v163, s59
  v_mfma_f32_16x16x32_bf16 v[64:67], v[24:27], v[12:15], v[64:67]
  s_nop 1
  v_mfma_f32_16x16x32_bf16 v[68:71], v[28:31], v[12:15], v[68:71]
  s_branch L_vtop
L_egB:
  s_cmp_lt_u32 s14, 16
  s_cbranch_scc1 L_egB0
  s_waitcnt lgkmcnt(0)
  s_sub_u32 s61, s8, s31
  s_cmp_gt_i32 s61, 80
  s_cbranch_scc1 L_lastA
  s_mul_i32 s61, s61, 16
  s_ashr_i32 s61, s61, 7
  s_sub_i32 s61, -6, s61
  s_max_i32 s62, s61, 0
  s_min_i32 s62, s62, 8
  s_sub_i32 s61, 0, s61
  s_max_i32 s61, s61, 0
  s_min_i32 s61, s61, 8
  s_bfm_b32 s11, s61, 12
  s_bfm_b32 s10, s62, 12
  s_lshr_b32 s61, s11, 16
  s_or_b32 s11, s11, s61
  s_lshr_b32 s61, s10, 16
  s_or_b32 s10, s10, s61
  s_branch L_egB1
L_hookK:
  v_mov_b32 v9, v6
  s_nop 1
  v_permlane16_swap_b32 v9, v6
  v_add_f32 v6, v6, v9
  v_mov_b32 v9, v6
  s_nop 1
  v_permlane32_swap_b32 v9, v6
  v_add_f32 v6, v6, v9
  s_lshl_b32 s61, s52, 2
  s_lshl_b32 s62, s72, 9
  s_add_u32 s61, s61, s62
  s_add_u32 s61, s61, 160000
  v_lshlrev_b32 v10, 6, v11
  v_add_u32 v10, s61, v10
  s_mov_b64 exec, 0xff
  ds_write_b32 v10, v5
  ds_write_b32 v10, v6 offset:32
  s_mov_b64 exec, -1
  v_mov_b32 v9, 161028
  v_mov_b32 v8, 1
  s_mov_b64 exec, 1
  ds_add_u32 v9, v8
  s_mov_b64 exec, -1
  s_cmp_eq_u32 s72, 1
  s_cbranch_scc1 L_kback
  s_mov_b32 s72, 1
  v_and_b32 v8, 7, v11
  v_lshrrev_b32 v9, 3, v11
  v_mul_u32_u24 v8, 272, v8
  v_lshl_add_u32 v8, v9, 4, v8
  s_mul_i32 s61, s72, 2176
  s_add_u32 s61, s61, 155648
  v_add_u32 v8, s61, v8
  ds_read_b128 v[32:35], v8 offset:0
  ds_read_b128 v[36:39], v8 offset:128
  v_mov_b32 v254, v253
  s_mov_b64 s[0:1], 0xff
  v_add_u32 v40, 28672, v40
  s_waitcnt lgkmcnt(0)
  v_mov_b32 v5, 0xff7fffff
  v_mov_b32 v6, 0
  s_branch L_kback
L_hookC:
  v_mov_b32 v9, 161028
L_cw0:
  ds_read_b32 v8, v9
  s_waitcnt lgkmcnt(0)
  v_readfirstlane_b32 s66, v8
  s_cmp_lt_u32 s66, 16
  s_cbranch_scc1 L_cw0
  v_and_b32 v8, 7, v11
  v_lshlrev_b32 v8, 6, v8
  v_add_u32 v8, 160000, v8
  s_lshl_b32 s61, s52, 2
  v_add_u32 v9, s61, v8
  ds_read_b128 v[72:75], v8 offset:0
  ds_read_b128 v[76:79], v8 offset:16
  ds_read_b128 v[80:83], v8 offset:32
  ds_read_b128 v[84:87], v8 offset:48
  ds_read_b32 v34, v9 offset:0
  ds_read_b128 v[88:91], v8 offset:512
  ds_read_b128 v[92:95], v8 offset:528
  ds_read_b128 v[96:99], v8 offset:544
  ds_read_b128 v[100:103], v8 offset:560
  ds_read_b32 v35, v9 offset:512
  s_lshl_b32 s63, s54, 4
  s_waitcnt lgkmcnt(0)
  s_load_dword s28, s[16:17], s63
  s_xor_b32 s63, s63, 16
  s_load_dword s32, s[16:17], s63
  v_max3_f32 v8, v72, v73, v74
  v_max3_f32 v9, v75, v76, v77
  v_max3_f32 v8, v8, v78, v79
  v_max_f32 v8, v8, v9
  v_sub_f32 v72, v72, v8
  v_sub_f32 v73, v73, v8
  v_sub_f32 v74, v74, v8
  v_sub_f32 v75, v75, v8
  v_sub_f32 v76, v76, v8
  v_sub_f32 v77, v77, v8
  v_sub_f32 v78, v78, v8
  v_sub_f32 v79, v79, v8
  v_sub_f32 v34, v34, v8
  v_exp_f32 v72, v72
  v_exp_f32 v73, v73
  v_exp_f32 v74, v74
  v_exp_f32 v75, v75
  v_exp_f32 v76, v76
  v_exp_f32 v77, v77
  v_exp_f32 v78, v78
  v_exp_f32 v79, v79
  v_exp_f32 v34, v34
  v_mul_f32 v9, v72, v80
  v_fmac_f32 v9, v73, v81
  v_fmac_f32 v9, v74, v82
  v_fmac_f32 v9, v75, v83
  v_fmac_f32 v9, v76, v84
  v_fmac_f32 v9, v77, v85
  v_fmac_f32 v9, v78, v86
  v_fmac_f32 v9, v79, v87
  v_rcp_f32 v9, v9
  s_nop 0
  v_mul_f32 v34, v34, v9
  v_max3_f32 v8, v88, v89, v90
  v_max3_f32 v9, v91, v92, v93
  v_max3_f32 v8, v8, v94, v95
  v_max_f32 v8, v8, v9
  v_sub_f32 v88, v88, v8
  v_sub_f32 v89, v89, v8
  v_sub_f32 v90, v90, v8
  v_sub_f32 v91, v91, v8
  v_sub_f32 v92, v92, v8
  v_sub_f32 v93, v93, v8
  v_sub_f32 v94, v94, v8
  v_sub_f32 v95, v95, v8
  v_sub_f32 v35, v35, v8
  v_exp_f32 v88, v88
  v_exp_f32 v89, v89
  v_exp_f32 v90, v90
  v_exp_f32 v91, v91
  v_exp_f32 v92, v92
  v_exp_f32 v93, v93
  v_exp_f32 v94, v94
  v_exp_f32 v95, v95
  v_exp_f32 v35, v35
  v_mul_f32 v9, v88, v96
  v_fmac_f32 v9, v89, v97
  v_fmac_f32 v9, v90, v98
  v_fmac_f32 v9, v91, v99
  v_fmac_f32 v9, v92, v100
  v_fmac_f32 v9, v93, v101
  v_fmac_f32 v9, v94, v102
  v_fmac_f32 v9, v95, v103
  v_rcp_f32 v9, v9
  s_nop 0
  v_mul_f32 v35, v35, v9
  s_lshl_b32 s61, s52, 12
  v_add_u32 v36, s61, v3
  s_and_b32 s61, s52, 1
  s_lshl_b32 s61, s61, 11
  s_lshr_b32 s62, s52, 1
  s_lshl_b32 s62, s62, 8
  s_add_u32 s61, s61, s62
  v_lshrrev_b32 v8, 5, v11
  v_lshlrev_b32 v37, 10, v8
  v_bfe_u32 v8, v11, 1, 1
  v_lshl_add_u32 v37, v8, 7, v37
  v_bfe_u32 v8, v11, 2, 3
  v_lshl_add_u32 v37, v8, 4, v37
  v_and_b32 v8, 1, v11
  v_lshl_add_u32 v37, v8, 3, v37
  v_add_u32 v37, s61, v37
  v_and_b32 v8, 7, v11
  v_lshrrev_b32 v9, 4, v11
  v_lshlrev_b32 v9, 7, v9
  v_lshl_add_u32 v38, v8, 4, v9
  v_bfe_u32 v9, v11, 3, 1
  v_mul_u32_u24 v5, 397312, v9
  v_add_u32 v38, v38, v5
  v_bfe_u32 v5, v11, 4, 1
  v_mul_u32_u24 v5, 12288, v5
  v_add_u32 v38, v38, v5
  v_lshlrev_b32 v39, 2, v11
  v_xor_b32 v5, 128, v252
  v_lshlrev_b32 v1, 11, v8
  v_lshl_add_u32 v1, v9, 4, v1
  v_lshrrev_b32 v9, 5, v11
  v_lshl_add_u32 v1, v9, 14, v1
  v_bfe_u32 v9, v11, 4, 1
  v_lshl_add_u32 v1, v9, 2, v1
  v_and_b32 v9, 1, v9
  v_lshlrev_b32 v9, 7, v9
  v_lshl_add_u32 v9, v8, 4, v9
  s_and_b32 s61, s52, 3
  s_lshl_b32 s61, s61, 8
  s_lshr_b32 s62, s52, 2
  s_lshl_b32 s62, s62, 7
  s_add_u32 s61, s61, s62
  s_add_u32 s61, s61, 65536
  v_xor_b32 v9, s61, v9
  v_lshrrev_b32 v8, 3, v11
  v_lshl_add_u32 v6, v8, 10, v9
  v_add_u32 v10, 45056, v6
  s_branch L_krest
L_lastA:
  buffer_load_dwordx4 v[136:139], v2, s[24:27], s4 offen nt
  buffer_load_dwordx4 v[140:143], v4, s[24:27], s4 offen nt
  buffer_load_dwordx4 v[144:147], v2, s[24:27], s5 offen nt
  buffer_load_dwordx4 v[148:151], v4, s[24:27], s5 offen nt
  buffer_load_dwordx4 v[152:155], v2, s[24:27], s6 offen nt
  buffer_load_dwordx4 v[156:159], v4, s[24:27], s6 offen nt
  buffer_load_dwordx4 v[160:163], v2, s[24:27], s7 offen nt
  buffer_load_dwordx4 v[164:167], v4, s[24:27], s7 offen nt
  s_waitcnt lgkmcnt(0)
  v_mul_f32 v40, v40, v7
  v_mul_f32 v41, v41, v7
  v_mul_f32 v42, v42, v7
  v_mul_f32 v43, v43, v7
  v_mul_f32 v44, v44, v7
  v_mul_f32 v45, v45, v7
  v_mul_f32 v46, v46, v7
  v_mul_f32 v47, v47, v7
  v_mul_f32 v48, v48, v7
  v_mul_f32 v49, v49, v7
  v_mul_f32 v50, v50, v7
  v_mul_f32 v51, v51, v7
  v_mul_f32 v52, v52, v7
  v_mul_f32 v53, v53, v7
  v_mul_f32 v54, v54, v7
  v_mul_f32 v55, v55, v7
  v_mul_f32 v56, v56, v7
  v_mul_f32 v57, v57, v7
  v_mul_f32 v58, v58, v7
  v_mul_f32 v59, v59, v7
  v_mul_f32 v60, v60, v7
  v_mul_f32 v61, v61, v7
  v_mul_f32 v62, v62, v7
  v_mul_f32 v63, v63, v7
  v_mul_f32 v64, v64, v7
  v_mul_f32 v65, v65, v7
  v_mul_f32 v66, v66, v7
  v_mul_f32 v67, v67, v7
  v_mul_f32 v68, v68, v7
  v_mul_f32 v69, v69, v7
  v_mul_f32 v70, v70, v7
  v_mul_f32 v71, v71, v7
  s_waitcnt vmcnt(8)
  v_perm_b32 v24, v108, v104, s58
  v_perm_b32 v25, v116, v112, s58
  v_perm_b32 v26, v124, v120, s58
  v_perm_b32 v27, v132, v128, s58
  v_perm_b32 v28, v108, v104, s59
  v_perm_b32 v29, v116, v112, s59
  v_perm_b32 v30, v124, v120, s59
  v_perm_b32 v31, v132, v128, s59
  v_mfma_f32_16x16x32_bf16 v[40:43], v[24:27], v[12:15], v[40:43]
  v_perm_b32 v24, v109, v105, s58
  v_perm_b32 v25, v117, v113, s58
  v_perm_b32 v26, v125, v121, s58
  v_perm_b32 v27, v133, v129, s58
  v_mfma_f32_16x16x32_bf16 v[44:47], v[28:31], v[12:15], v[44:47]
  v_perm_b32 v28, v109, v105, s59
  v_perm_b32 v29, v117, v113, s59
  v_perm_b32 v30, v125, v121, s59
  v_perm_b32 v31, v133, v129, s59
  v_mfma_f32_16x16x32_bf16 v[48:51], v[24:27], v[12:15], v[48:51]
  v_perm_b32 v24, v110, v106, s58
  v_perm_b32 v25, v118, v114, s58
  v_perm_b32 v26, v126, v122, s58
  v_perm_b32 v27, v134, v130, s58
  v_mfma_f32_16x16x32_bf16 v[52:55], v[28:31], v[12:15], v[52:55]
  v_perm_b32 v28, v110, v106, s59
  v_perm_b32 v29, v118, v114, s59
  v_perm_b32 v30, v126, v122, s59
  v_perm_b32 v31, v134, v130, s59
  v_mfma_f32_16x16x32_bf16 v[56:59], v[24:27], v[12:15], v[56:59]
  v_perm_b32 v24, v111, v107, s58
  v_perm_b32 v25, v119, v115, s58
  v_perm_b32 v26, v127, v123, s58
  v_perm_b32 v27, v135, v131, s58
  v_mfma_f32_16x16x32_bf16 v[60:63], v[28:31], v[12:15], v[60:63]
  v_perm_b32 v28, v111, v107, s59
  v_perm_b32 v29, v119, v115, s59
  v_perm_b32 v30, v127, v123, s59
  v_perm_b32 v31, v135, v131, s59
  v_mfma_f32_16x16x32_bf16 v[64:67], v[24:27], v[12:15], v[64:67]
  s_nop 1
  v_mfma_f32_16x16x32_bf16 v[68:71], v[28:31], v[12:15], v[68:71]
  ds_read_b128 v[12:15], v32
  ds_bpermute_b32 v7, v33, v254
  v_add_u32 v32, 512, v32
  v_add_u32 v33, 32, v33
  s_nop 4
L_last:
  s_waitcnt lgkmcnt(0)
  v_mul_f32 v40, v40, v7
  v_mul_f32 v41, v41, v7
  v_mul_f32 v42, v42, v7
  v_mul_f32 v43, v43, v7
  v_mul_f32 v44, v44, v7
  v_mul_f32 v45, v45, v7
  v_mul_f32 v46, v46, v7
  v_mul_f32 v47, v47, v7
  v_mul_f32 v48, v48, v7
  v_mul_f32 v49, v49, v7
  v_mul_f32 v50, v50, v7
  v_mul_f32 v51, v51, v7
  v_mul_f32 v52, v52, v7
  v_mul_f32 v53, v53, v7
  v_mul_f32 v54, v54, v7
  v_mul_f32 v55, v55, v7
  v_mul_f32 v56, v56, v7
  v_mul_f32 v57, v57, v7
  v_mul_f32 v58, v58, v7
  v_mul_f32 v59, v59, v7
  v_mul_f32 v60, v60, v7
  v_mul_f32 v61, v61, v7
  v_mul_f32 v62, v62, v7
  v_mul_f32 v63, v63, v7
  v_mul_f32 v64, v64, v7
  v_mul_f32 v65, v65, v7
  v_mul_f32 v66, v66, v7
  v_mul_f32 v67, v67, v7
  v_mul_f32 v68, v68, v7
  v_mul_f32 v69, v69, v7
  v_mul_f32 v70, v70, v7
  v_mul_f32 v71, v71, v7
  s_lshl_b32 s63, s54, 4
  s_xor_b32 s64, s63, 16
  s_mov_b32 s65, 0
L_hspoll:
  s_and_b32 s61, s28, s32
  s_bitcmp1_b32 s61, 5
  s_cbranch_scc1 L_hsok
  buffer_load_dword v8, off, s[48:51], s63 sc1
  buffer_load_dword v9, off, s[48:51], s64 sc1
  s_sleep 8
  s_waitcnt vmcnt(0)
  v_readfirstlane_b32 s28, v8
  v_readfirstlane_b32 s32, v9
  s_add_u32 s65, s65, 1
  s_cmp_lt_u32 s65, 0x20000
  s_cbranch_scc1 L_hspoll
L_hsok:
  s_mov_b32 s79, 0
  s_getreg_b32 s63, hwreg(HW_REG_XCC_ID, 0, 4)
  s_sub_u32 s63, s63, s2
  s_and_b32 s63, s63, 7
  s_mul_i32 s64, s63, s63
  s_lshl_b32 s64, s64, 8
  s_add_u32 s64, s64, s63
  s_lshl_b32 s64, s64, 6
  s_add_u32 s64, s64, 1
  s_lshl_b32 s64, s64, 5
  s_sub_u32 s28, s28, s64
  v_mov_b32 v9, 161024
L_cw1:
  ds_read_b32 v8, v9
  s_waitcnt lgkmcnt(0)
  v_readfirstlane_b32 s66, v8
  s_cmp_lt_u32 s66, 8
  s_cbranch_scc1 L_cw1
  s_lshl_b32 s80, s52, 8
  s_add_u32 s80, s80, s69
  s_add_u32 s80, s80, 8192
  s_lshr_b32 s64, s52, 2
  s_and_b32 s86, s54, 6
  s_add_u32 s86, s86, s64
  s_lshl_b32 s86, s86, 15
  s_and_b32 s63, s54, 1
  s_lshl_b32 s63, s63, 7
  s_add_u32 s86, s86, s63
  s_lshl_b32 s81, s52, 10
  s_add_u32 s81, s81, s69
  s_lshl_b32 s63, s52, 10
  s_add_u32 s63, s63, s29
  s_xor_b32 s83, s53, 1
  s_mul_i32 s83, s83, 12416
  s_add_u32 s83, s83, s63
  s_xor_b32 s84, s53, 2
  s_mul_i32 s84, s84, 12416
  s_add_u32 s84, s84, s63
  s_xor_b32 s85, s53, 3
  s_mul_i32 s85, s85, 12416
  s_add_u32 s85, s85, s63
  s_and_b32 s82, s52, 3
  s_sub_u32 s82, s82, s3
  s_lshl_b32 s63, s55, 8
  s_add_u32 s86, s86, s63
  s_lshl_b32 s63, s3, 5
  s_add_u32 s86, s86, s63
  s_mov_b32 s88, 0x11111111
  s_mov_b32 s89, s88
  s_branch L_c2
L_pvf:
  v_perm_b32 v24, v140, v136, s58
  v_perm_b32 v25, v148, v144, s58
  v_perm_b32 v26, v156, v152, s58
  v_perm_b32 v27, v164, v160, s58
  v_perm_b32 v28, v140, v136, s59
  v_perm_b32 v29, v148, v144, s59
  v_perm_b32 v30, v156, v152, s59
  v_perm_b32 v31, v164, v160, s59
  v_mfma_f32_16x16x32_bf16 v[40:43], v[24:27], v[12:15], v[40:43]
  v_perm_b32 v24, v141, v137, s58
  v_perm_b32 v25, v149, v145, s58
  v_perm_b32 v26, v157, v153, s58
  v_perm_b32 v27, v165, v161, s58
  v_mfma_f32_16x16x32_bf16 v[44:47], v[28:31], v[12:15], v[44:47]
  v_perm_b32 v28, v141, v137, s59
  v_perm_b32 v29, v149, v145, s59
  v_perm_b32 v30, v157, v153, s59
  v_perm_b32 v31, v165, v161, s59
  v_mfma_f32_16x16x32_bf16 v[48:51], v[24:27], v[12:15], v[48:51]
  v_perm_b32 v24, v142, v138, s58
  v_perm_b32 v25, v150, v146, s58
  v_perm_b32 v26, v158, v154, s58
  v_perm_b32 v27, v166, v162, s58
  v_mfma_f32_16x16x32_bf16 v[52:55], v[28:31], v[12:15], v[52:55]
  v_mul_f32 v40, v40, v34
  v_mul_f32 v41, v41, v34
  v_mul_f32 v42, v42, v34
  v_mul_f32 v43, v43, v34
  v_mul_f32_dpp v40, v44, v34 row_shr:8 row_mask:0xf bank_mask:0xc
  v_mul_f32_dpp v41, v45, v34 row_shr:8 row_mask:0xf bank_mask:0xc
  v_mul_f32_dpp v42, v46, v34 row_shr:8 row_mask:0xf bank_mask:0xc
  v_mul_f32_dpp v43, v47, v34 row_shr:8 row_mask:0xf bank_mask:0xc
  ds_write_b128 v36, v[40:43] offset:0
  v_perm_b32 v28, v142, v138, s59
  v_perm_b32 v29, v150, v146, s59
  v_perm_b32 v30, v158, v154, s59
  v_perm_b32 v31, v166, v162, s59
  v_mfma_f32_16x16x32_bf16 v[56:59], v[24:27], v[12:15], v[56:59]
  v_perm_b32 v24, v143, v139, s58
  v_perm_b32 v25, v151, v147, s58
  v_perm_b32 v26, v159, v155, s58
  v_perm_b32 v27, v167, v163, s58
  v_mfma_f32_16x16x32_bf16 v[60:63], v[28:31], v[12:15], v[60:63]
  v_mul_f32 v48, v48, v34
  v_mul_f32 v49, v49, v34
  v_mul_f32 v50, v50, v34
  v_mul_f32 v51, v51, v34
  v_mul_f32_dpp v48, v52, v34 row_shr:8 row_mask:0xf bank_mask:0xc
  v_mul_f32_dpp v49, v53, v34 row_shr:8 row_mask:0xf bank_mask:0xc
  v_mul_f32_dpp v50, v54, v34 row_shr:8 row_mask:0xf bank_mask:0xc
  v_mul_f32_dpp v51, v55, v34 row_shr:8 row_mask:0xf bank_mask:0xc
  ds_write_b128 v36, v[48:51] offset:1024
  v_perm_b32 v28, v143, v139, s59
  v_perm_b32 v29, v151, v147, s59
  v_perm_b32 v30, v159, v155, s59
  v_perm_b32 v31, v167, v163, s59
  v_mfma_f32_16x16x32_bf16 v[64:67], v[24:27], v[12:15], v[64:67]
  s_nop 1
  v_mfma_f32_16x16x32_bf16 v[68:71], v[28:31], v[12:15], v[68:71]
  v_mul_f32 v56, v56, v34
  v_mul_f32 v57, v57, v34
  v_mul_f32 v58, v58, v34
  v_mul_f32 v59, v59, v34
  v_mul_f32_dpp v56, v60, v34 row_shr:8 row_mask:0xf bank_mask:0xc
  v_mul_f32_dpp v57, v61, v34 row_shr:8 row_mask:0xf bank_mask:0xc
  v_mul_f32_dpp v58, v62, v34 row_shr:8 row_mask:0xf bank_mask:0xc
  v_mul_f32_dpp v59, v63, v34 row_shr:8 row_mask:0xf bank_mask:0xc
  ds_write_b128 v36, v[56:59] offset:2048
  v_mul_f32 v64, v64, v34
  v_mul_f32 v65, v65, v34
  v_mul_f32 v66, v66, v34
  v_mul_f32 v67, v67, v34
  v_mul_f32_dpp v64, v68, v34 row_shr:8 row_mask:0xf bank_mask:0xc
  v_mul_f32_dpp v65, v69, v34 row_shr:8 row_mask:0xf bank_mask:0xc
  v_mul_f32_dpp v66, v70, v34 row_shr:8 row_mask:0xf bank_mask:0xc
  v_mul_f32_dpp v67, v71, v34 row_shr:8 row_mask:0xf bank_mask:0xc
  ds_write_b128 v36, v[64:67] offset:3072
  s_cmp_eq_u32 s73, 15
  s_cbranch_scc1 L_c2b
  v_mov_b32 v9, 161024
  v_mov_b32 v8, 1
  s_mov_b64 exec, 1
  ds_add_u32 v9, v8
  s_mov_b64 exec, -1
  v_mov_b32 v254, v253
  v_mov_b32 v34, v35
  v_add_u32 v32, 28672, v32
  v_and_b32 v33, 31, v33
  s_waitcnt lgkmcnt(0)
  v_add_u32 v36, 32768, v36
  v_mov_b32 v40, 0
  v_mov_b32 v41, 0
  v_mov_b32 v42, 0
  v_mov_b32 v43, 0
  v_mov_b32 v44, 0
  v_mov_b32 v45, 0
  v_mov_b32 v46, 0
  v_mov_b32 v47, 0
  v_mov_b32 v48, 0
  v_mov_b32 v49, 0
  v_mov_b32 v50, 0
  v_mov_b32 v51, 0
  v_mov_b32 v52, 0
  v_mov_b32 v53, 0
  v_mov_b32 v54, 0
  v_mov_b32 v55, 0
  v_mov_b32 v56, 0
  v_mov_b32 v57, 0
  v_mov_b32 v58, 0
  v_mov_b32 v59, 0
  v_mov_b32 v60, 0
  v_mov_b32 v61, 0
  v_mov_b32 v62, 0
  v_mov_b32 v63, 0
  v_mov_b32 v64, 0
  v_mov_b32 v65, 0
  v_mov_b32 v66, 0
  v_mov_b32 v67, 0
  v_mov_b32 v68, 0
  v_mov_b32 v69, 0
  v_mov_b32 v70, 0
  v_mov_b32 v71, 0
  s_branch L_krest
L_c2b:
  s_waitcnt lgkmcnt(0)
  s_barrier
L_c2:
  ds_read_b64 v[88:89], v37 offset:0
  ds_read_b64 v[90:91], v37 offset:4096
  ds_read_b64 v[92:93], v37 offset:8192
  ds_read_b64 v[94:95], v37 offset:12288
  ds_read_b64 v[96:97], v37 offset:16384
  ds_read_b64 v[98:99], v37 offset:20480
  ds_read_b64 v[100:101], v37 offset:24576
  ds_read_b64 v[102:103], v37 offset:28672
L_c2r:
  s_waitcnt lgkmcnt(3)
  v_add_f32 v88, v88, v96
  v_add_f32 v89, v89, v97
  s_waitcnt lgkmcnt(2)
  v_add_f32 v90, v90, v98
  v_add_f32 v91, v91, v99
  s_waitcnt lgkmcnt(1)
  v_add_f32 v92, v92, v100
  v_add_f32 v93, v93, v101
  s_waitcnt lgkmcnt(0)
  v_add_f32 v94, v94, v102
  v_add_f32 v95, v95, v103
  v_add_f32 v88, v88, v92
  v_add_f32 v89, v89, v93
  v_add_f32 v90, v90, v94
  v_add_f32 v91, v91, v95
  v_add_f32 v88, v88, v90
  v_add_f32 v89, v89, v91
  v_cvt_pk_bf16_f32 v72, v88, v89
  v_min_u32 v72, -2, v72
  s_nop 1
  v_mov_b32_dpp v73, v72 quad_perm:[1,1,1,1] row_mask:0xf bank_mask:0xf
  v_mov_b32_dpp v74, v72 quad_perm:[2,2,2,2] row_mask:0xf bank_mask:0xf
  v_mov_b32_dpp v75, v72 quad_perm:[3,3,3,3] row_mask:0xf bank_mask:0xf
  s_cmp_eq_u32 s79, 1
  s_cbranch_scc1 L_ob1
  v_mov_b32 v76, v72
  v_mov_b32 v77, v73
  v_mov_b32 v78, v74
  v_mov_b32 v79, v75
  s_mov_b32 s79, 1
  v_add_u32 v37, 32768, v37
  s_waitcnt vmcnt(0)
  s_mov_b64 exec, s[88:89]
  buffer_store_dwordx4 v[76:79], v39, s[40:43], s80 offen sc1
  s_mov_b64 exec, -1
  s_branch L_pvf
L_ob1:
  s_mov_b64 exec, s[88:89]
  buffer_store_dwordx4 v[72:75], v39, s[40:43], s80 offen offset:2048 sc1
  s_mov_b64 exec, -1
L_hookO:
  s_mov_b32 s65, 0
  buffer_load_dwordx4 v[232:235], v38, s[40:43], s34 offen offset:0 sc1
  buffer_load_dwordx4 v[236:239], v38, s[40:43], s34 offen offset:512 sc1
  buffer_load_dwordx4 v[240:243], v38, s[40:43], s34 offen offset:1024 sc1
  buffer_load_dwordx4 v[244:247], v38, s[40:43], s34 offen offset:1536 sc1
  s_waitcnt vmcnt(0)
L_h0chk:
  v_max3_u32 v8, v232, v233, v234
  v_max3_u32 v9, v235, v236, v237
  v_max3_u32 v8, v8, v238, v239
  v_max3_u32 v9, v9, v240, v241
  v_max3_u32 v8, v8, v242, v243
  v_max3_u32 v9, v9, v244, v245
  v_max3_u32 v8, v8, v246, v247
  v_max_u32 v8, v8, v9
  v_cmp_eq_u32 vcc, -1, v8
  s_cbranch_vccz L_h0ok
  s_mov_b64 exec, vcc
  buffer_load_dwordx4 v[232:235], v38, s[40:43], s34 offen offset:0 sc1
  buffer_load_dwordx4 v[236:239], v38, s[40:43], s34 offen offset:512 sc1
  buffer_load_dwordx4 v[240:243], v38, s[40:43], s34 offen offset:1024 sc1
  buffer_load_dwordx4 v[244:247], v38, s[40:43], s34 offen offset:1536 sc1
  s_waitcnt vmcnt(0)
  s_add_u32 s65, s65, 1
  s_cmp_lt_u32 s65, 0x20000
  s_cbranch_scc1 L_h0chk
L_h0ok:
  s_mov_b64 exec, -1
  v_mfma_f32_16x16x32_bf16 v[72:75], v[168:171], v[232:235], 0
  v_mfma_f32_16x16x32_bf16 v[72:75], v[184:187], v[236:239], v[72:75]
  v_mfma_f32_16x16x32_bf16 v[72:75], v[200:203], v[240:243], v[72:75]
  v_mfma_f32_16x16x32_bf16 v[72:75], v[216:219], v[244:247], v[72:75]
  v_mfma_f32_16x16x32_bf16 v[76:79], v[172:175], v[232:235], 0
  v_mfma_f32_16x16x32_bf16 v[76:79], v[188:191], v[236:239], v[76:79]
  v_mfma_f32_16x16x32_bf16 v[76:79], v[204:207], v[240:243], v[76:79]
  v_mfma_f32_16x16x32_bf16 v[76:79], v[220:223], v[244:247], v[76:79]
  v_mfma_f32_16x16x32_bf16 v[80:83], v[176:179], v[232:235], 0
  v_mfma_f32_16x16x32_bf16 v[80:83], v[192:195], v[236:239], v[80:83]
  v_mfma_f32_16x16x32_bf16 v[80:83], v[208:211], v[240:243], v[80:83]
  v_mfma_f32_16x16x32_bf16 v[80:83], v[224:227], v[244:247], v[80:83]
  ds_write_b128 v252, v[72:75] offset:0
  v_mfma_f32_16x16x32_bf16 v[84:87], v[180:183], v[232:235], 0
  v_mfma_f32_16x16x32_bf16 v[84:87], v[196:199], v[236:239], v[84:87]
  v_mfma_f32_16x16x32_bf16 v[84:87], v[212:215], v[240:243], v[84:87]
  v_mfma_f32_16x16x32_bf16 v[84:87], v[228:231], v[244:247], v[84:87]
  ds_write_b128 v252, v[76:79] offset:1024
  s_nop 2
  ds_write_b128 v5, v[80:83] offset:2048
  s_nop 2
  ds_write_b128 v5, v[84:87] offset:3072
  buffer_load_dwordx4 v[16:19], v38, s[40:43], s34 offen offset:2048 sc1
  buffer_load_dwordx4 v[20:23], v38, s[40:43], s34 offen offset:2560 sc1
  buffer_load_dwordx4 v[24:27], v38, s[40:43], s34 offen offset:3072 sc1
  buffer_load_dwordx4 v[28:31], v38, s[40:43], s34 offen offset:3584 sc1
  s_branch L_pw
L_poll:
  buffer_load_dwordx4 v[16:19], v38, s[40:43], s34 offen offset:2048 sc1
  buffer_load_dwordx4 v[20:23], v38, s[40:43], s34 offen offset:2560 sc1
  buffer_load_dwordx4 v[24:27], v38, s[40:43], s34 offen offset:3072 sc1
  buffer_load_dwordx4 v[28:31], v38, s[40:43], s34 offen offset:3584 sc1
L_pw:
  s_waitcnt vmcnt(0)
  v_max3_u32 v8, v16, v17, v18
  v_max3_u32 v9, v19, v20, v21
  v_max3_u32 v8, v8, v22, v23
  v_max3_u32 v9, v9, v24, v25
  v_max3_u32 v8, v8, v26, v27
  v_max3_u32 v9, v9, v28, v29
  v_max3_u32 v8, v8, v30, v31
  v_max_u32 v8, v8, v9
  v_cmp_eq_u32 vcc, -1, v8
  s_cbranch_vccz L_polled
  s_mov_b64 exec, vcc
  s_add_u32 s65, s65, 1
  s_cmp_lt_u32 s65, 0x20000
  s_cbranch_scc1 L_poll
L_polled:
  s_mov_b64 exec, -1
  s_cmp_lg_u32 s82, 0
  s_cbranch_scc1 L_npw
  buffer_load_dwordx4 v[44:47], v3, s[40:43], s83 offen sc1
  buffer_load_dwordx4 v[48:51], v3, s[40:43], s84 offen sc1
  buffer_load_dwordx4 v[52:55], v3, s[40:43], s85 offen sc1
L_npw:
  s_waitcnt lgkmcnt(0)
  v_mfma_f32_16x16x32_bf16 v[72:75], v[168:171], v[16:19], 0
  v_mfma_f32_16x16x32_bf16 v[72:75], v[184:187], v[20:23], v[72:75]
  v_mfma_f32_16x16x32_bf16 v[72:75], v[200:203], v[24:27], v[72:75]
  v_mfma_f32_16x16x32_bf16 v[72:75], v[216:219], v[28:31], v[72:75]
  v_mfma_f32_16x16x32_bf16 v[76:79], v[172:175], v[16:19], 0
  v_mfma_f32_16x16x32_bf16 v[76:79], v[188:191], v[20:23], v[76:79]
  v_mfma_f32_16x16x32_bf16 v[76:79], v[204:207], v[24:27], v[76:79]
  v_mfma_f32_16x16x32_bf16 v[76:79], v[220:223], v[28:31], v[76:79]
  v_mfma_f32_16x16x32_bf16 v[80:83], v[176:179], v[16:19], 0
  v_mfma_f32_16x16x32_bf16 v[80:83], v[192:195], v[20:23], v[80:83]
  v_mfma_f32_16x16x32_bf16 v[80:83], v[208:211], v[24:27], v[80:83]
  v_mfma_f32_16x16x32_bf16 v[80:83], v[224:227], v[28:31], v[80:83]
  ds_write_b128 v252, v[72:75] offset:4096
  v_mfma_f32_16x16x32_bf16 v[84:87], v[180:183], v[16:19], 0
  v_mfma_f32_16x16x32_bf16 v[84:87], v[196:199], v[20:23], v[84:87]
  v_mfma_f32_16x16x32_bf16 v[84:87], v[212:215], v[24:27], v[84:87]
  v_mfma_f32_16x16x32_bf16 v[84:87], v[228:231], v[28:31], v[84:87]
  ds_write_b128 v252, v[76:79] offset:5120
  s_nop 2
  ds_write_b128 v5, v[80:83] offset:6144
  s_nop 2
  ds_write_b128 v5, v[84:87] offset:7168
  s_waitcnt lgkmcnt(0)
  s_barrier
  ds_read_b128 v[72:75], v6 offset:0
  ds_read_b128 v[76:79], v6 offset:11264
  ds_read_b128 v[80:83], v6 offset:22528
  ds_read_b128 v[84:87], v6 offset:33792
  ds_read_b128 v[88:91], v10 offset:0
  ds_read_b128 v[92:95], v10 offset:11264
  ds_read_b128 v[96:99], v10 offset:22528
  ds_read_b128 v[100:103], v10 offset:33792
  s_cmp_lg_u32 s82, 0
  s_cbranch_scc1 L_nfp
  buffer_load_dwordx4 v[20:23], v3, s[40:43], s83 offen sc1
  buffer_load_dwordx4 v[24:27], v3, s[40:43], s84 offen sc1
  buffer_load_dwordx4 v[28:31], v3, s[40:43], s85 offen sc1
L_nfp:
  s_waitcnt lgkmcnt(3)
  v_add_f32 v72, v72, v88
  v_add_f32 v73, v73, v89
  v_add_f32 v74, v74, v90
  v_add_f32 v75, v75, v91
  s_waitcnt lgkmcnt(2)
  v_add_f32 v76, v76, v92
  v_add_f32 v77, v77, v93
  v_add_f32 v78, v78, v94
  v_add_f32 v79, v79, v95
  s_waitcnt lgkmcnt(1)
  v_add_f32 v80, v80, v96
  v_add_f32 v81, v81, v97
  v_add_f32 v82, v82, v98
  v_add_f32 v83, v83, v99
  s_waitcnt lgkmcnt(0)
  v_add_f32 v84, v84, v100
  v_add_f32 v85, v85, v101
  v_add_f32 v86, v86, v102
  v_add_f32 v87, v87, v103
  v_add_f32 v72, v72, v80
  v_add_f32 v73, v73, v81
  v_add_f32 v74, v74, v82
  v_add_f32 v75, v75, v83
  v_add_f32 v76, v76, v84
  v_add_f32 v77, v77, v85
  v_add_f32 v78, v78, v86
  v_add_f32 v79, v79, v87
  v_add_f32 v72, v72, v76
  v_add_f32 v73, v73, v77
  v_add_f32 v74, v74, v78
  v_add_f32 v75, v75, v79
  s_cmp_eq_u32 s82, 0
  s_cbranch_scc1 L_fown
  v_min_u32 v72, -2, v72
  v_min_u32 v73, -2, v73
  v_min_u32 v74, -2, v74
  v_min_u32 v75, -2, v75
  s_cmp_lg_u32 s28, 0
  s_cbranch_scc1 L_pslow
  buffer_store_dwordx4 v[72:75], v3, s[40:43], s81 offen
  s_branch L_pdone
L_pslow:
  buffer_store_dwordx4 v[72:75], v3, s[40:43], s81 offen sc1
L_pdone:
  s_branch L_fin
L_fown:
  s_mov_b32 s65, 0
  s_branch L_fpw
L_fpoll:
  buffer_load_dwordx4 v[20:23], v3, s[40:43], s83 offen sc1
  buffer_load_dwordx4 v[24:27], v3, s[40:43], s84 offen sc1
  buffer_load_dwordx4 v[28:31], v3, s[40:43], s85 offen sc1
L_fpw:
  s_waitcnt vmcnt(0)
  v_max3_u32 v8, v20, v21, v22
  v_max3_u32 v9, v23, v24, v25
  v_max3_u32 v8, v8, v26, v27
  v_max3_u32 v9, v9, v28, v29
  v_max3_u32 v8, v8, v30, v31
  v_max_u32 v8, v8, v9
  v_cmp_eq_u32 vcc, -1, v8
  s_cbranch_vccz L_fpolled
  s_add_u32 s65, s65, 1
  s_cmp_lt_u32 s65, 0x20000
  s_cbranch_scc1 L_fpoll
L_fpolled:
  v_add_f32 v16, v72, v20
  v_add_f32 v24, v24, v28
  v_add_f32 v17, v73, v21
  v_add_f32 v25, v25, v29
  v_add_f32 v18, v74, v22
  v_add_f32 v26, v26, v30
  v_add_f32 v19, v75, v23
  v_add_f32 v27, v27, v31
  v_add_f32 v16, v16, v24
  v_add_f32 v17, v17, v25
  v_add_f32 v18, v18, v26
  v_add_f32 v19, v19, v27
  s_nop 1
  v_mov_b32_dpp v20, v18 row_ror:8 row_mask:0xf bank_mask:0xf
  v_mov_b32_dpp v18, v16 row_ror:8 row_mask:0xf bank_mask:0x3
  v_mov_b32_dpp v21, v19 row_ror:8 row_mask:0xf bank_mask:0xf
  v_mov_b32_dpp v19, v17 row_ror:8 row_mask:0xf bank_mask:0x3
  v_cndmask_b32 v16, v20, v16, s[70:71]
  v_cndmask_b32 v17, v21, v17, s[70:71]
  v_cvt_pk_bf16_f32 v16, v16, v18
  v_cvt_pk_bf16_f32 v17, v17, v19
  buffer_store_dword v16, v1, s[44:47], s86 offen offset:0
  buffer_store_dword v17, v1, s[44:47], s86 offen offset:8
L_fin:
L_end:
  s_endpgm
.section .rodata,"a"
.p2align 6
.amdhsa_kernel standalone__mha_block_cached__sampling_kernel
  .amdhsa_next_free_vgpr 256
  .amdhsa_next_free_sgpr 102
  .amdhsa_accum_offset 256
  .amdhsa_group_segment_fixed_size 0
  .amdhsa_kernarg_size 64
  .amdhsa_user_sgpr_count 2
  .amdhsa_user_sgpr_kernarg_segment_ptr 1
  .amdhsa_system_sgpr_workgroup_id_x 1
  .amdhsa_float_denorm_mode_32 3
  .amdhsa_float_denorm_mode_16_64 3
.end_amdhsa_kernel
```
